```python
import torch

def _softmax(x, axis=-1):
    return torch.softmax(x, dim=axis)
def _gelu(x):
    return torch.nn.functional.gelu(x, approximate="tanh")
def _silu(x):
    return torch.nn.functional.silu(x)
def _sigmoid(x):
    return torch.sigmoid(x)
def _layernorm(x, axis=-1, eps=1e-5):
    m = x.mean(dim=axis, keepdim=True)
    v = x.var(dim=axis, keepdim=True, unbiased=False)
    return (x - m) / torch.sqrt(v + eps)
def _scatter_add(tgt, idx, src, axis=0):
    return tgt.clone().index_add_(axis, idx, src)
def _segment_sum(src, seg, n):
    out = torch.zeros((n,) + src.shape[1:], dtype=src.dtype)
    return out.index_add_(0, seg, src)
def _pad(x, pw):
    flat = tuple(v for pair in reversed(pw) for v in pair)
    return torch.nn.functional.pad(x, flat)

kernel_name = 'interleave_layers__sliding_block_cached__glu_gated_swiglu__decode'

def setup_inputs():

    _w = (lambda a: (lambda t: t.to(torch.bfloat16) if t.is_floating_point() else t)(torch.as_tensor(a)))
    def _A_setup():
        B, Sq, D = 1, 1, 512
        Hq, Hkv, Sk, Dh = 32, 8, 32768, 128
        assert Hq % Hkv == 0, (Hq, Hkv)
        return {
            "x": _w((lambda *s: torch.randn(*s, dtype=torch.bfloat16) * 0.05)(B, Sq, D)),
            "k_cache": _w((lambda *s: torch.randn(*s, dtype=torch.bfloat16) * 0.8)(B, Hkv, Sk, Dh)),
            "v_cache": _w((lambda *s: torch.randn(*s, dtype=torch.bfloat16) * 0.8)(B, Hkv, Sk, Dh)),
            "wq": _w((lambda *s: torch.randn(*s, dtype=torch.bfloat16) * 0.8)(D, Hq * Dh) * (D ** -0.5)),
            "wo": _w((lambda *s: torch.randn(*s, dtype=torch.bfloat16) * 0.8)(Hq * Dh, D) * ((Hq * Dh) ** -0.5)),
        }
    _A_in = _A_setup()

    def _B_setup():
        B, S, D, F = 1, 1, 512, 1792
        return {
            "x": _w((lambda *s: torch.randn(*s, dtype=torch.bfloat16) * 0.05)(B, S, D)),
            "w1": _w((lambda *s: torch.randn(*s, dtype=torch.bfloat16) * 0.2)(D, F) * (2.0 / D) ** 0.5),
            "w3": _w((lambda *s: torch.randn(*s, dtype=torch.bfloat16) * 0.2)(D, F) * (2.0 / D) ** 0.5),
            "w2": _w((lambda *s: torch.randn(*s, dtype=torch.bfloat16) * 0.2)(F, D) * (2.0 / F) ** 0.5),
        }
    _B_in = _B_setup()

    return {
        "A_x": _A_in["x"],
        "A_k_cache": _A_in["k_cache"],
        "A_v_cache": _A_in["v_cache"],
        "A_wq": _A_in["wq"],
        "A_wo": _A_in["wo"],
        "B_x": _B_in["x"],
        "B_w1": _B_in["w1"],
        "B_w3": _B_in["w3"],
        "B_w2": _B_in["w2"],
    }

def reference(A_x, A_k_cache, A_v_cache, A_wq, A_wo, B_x, B_w1, B_w3, B_w2):
    def _A_ref(x, k_cache, v_cache, wq, wo):
        B, Sq, D = x.shape
        Hq, Dh = 32, 128
        Hkv, Sk = k_cache.shape[1], k_cache.shape[2]
        W = min(4096, max(256, Sk // 4))
        rep = Hq // Hkv
        q = (lambda x, *d: x.permute(*d))((x @ wq).reshape(B, Sq, Hq, Dh), 0, 2, 1, 3)
        k = (lambda x, n, axis: torch.repeat_interleave(x, n, dim=axis))(k_cache[:, :, Sk - W:, :], rep, axis=1)
        v = (lambda x, n, axis: torch.repeat_interleave(x, n, dim=axis))(v_cache[:, :, Sk - W:, :], rep, axis=1)
        scores = torch.einsum("bhqd,bhkd->bhqk", q, k) * (Dh ** -0.5)
        p = _softmax(scores, axis=-1)
        o = torch.einsum("bhqk,bhkd->bhqd", p, v)
        return (lambda x, *d: x.permute(*d))(o, 0, 2, 1, 3).reshape(B, Sq, Hq * Dh) @ wo

    def _B_ref(x, w1, w3, w2):
        gate = torch.einsum("bsd,df->bsf", x, w1)
        up = torch.einsum("bsd,df->bsf", x, w3)
        h = _silu(gate) * up
        out = torch.einsum("bsf,fd->bsd", h, w2)
        return out

    x = A_x
    x = x + _A_ref(_layernorm(x, axis=-1), A_k_cache, A_v_cache, A_wq, A_wo)
    x = x + _B_ref(_layernorm(x, axis=-1), B_w1, B_w3, B_w2)
    x = x + _A_ref(_layernorm(x, axis=-1), A_k_cache, A_v_cache, A_wq, A_wo)
    x = x + _B_ref(_layernorm(x, axis=-1), B_w1, B_w3, B_w2)
    return x
```

```asm
; @launch grid=(256,1,1) block=(256,1,1) lds=118784
.amdgcn_target "amdgcn-amd-amdhsa--gfx950"
.text
.globl interleave_layers__sliding_block_cached__glu_gated_swiglu__decode_kernel
.p2align 8
.type interleave_layers__sliding_block_cached__glu_gated_swiglu__decode_kernel,@function
interleave_layers__sliding_block_cached__glu_gated_swiglu__decode_kernel:
    s_cmp_ge_u32 s2, 256
    s_cbranch_scc1 L_exit
    s_load_dwordx2 s[52:53], s[0:1], 24
    s_load_dwordx2 s[48:49], s[0:1], 16
    s_load_dwordx2 s[44:45], s[0:1], 8
    s_load_dwordx2 s[80:81], s[0:1], 88
    s_load_dwordx2 s[40:41], s[0:1], 0
    v_and_b32 v1, 63, v0
    v_lshrrev_b32 v222, 6, v0
    s_and_b32 s4, s2, 7
    v_readfirstlane_b32 s6, v222
    s_lshr_b32 s5, s2, 3
    s_and_b32 s7, s5, 15
    v_lshlrev_b32 v2, 4, v1
    s_mov_b32 s54, 4194304
    s_mov_b32 s55, 0x20000
    s_mov_b32 s50, 67108864
    s_mov_b32 s51, 0x20000
    s_mov_b32 s46, 67108864
    s_mov_b32 s47, 0x20000
    s_mov_b32 s82, 268435456
    s_mov_b32 s83, 0x20000
    s_mov_b32 s42, 1024
    s_mov_b32 s43, 0x20000
    s_getreg_b32 s39, hwreg(HW_REG_XCC_ID, 0, 4)
    s_mov_b32 s16, 0
    s_mov_b32 s36, 0
    s_waitcnt lgkmcnt(0)
    s_load_dword s14, s[80:81], 77824
    s_load_dwordx2 s[56:57], s[0:1], 32
    s_load_dwordx2 s[60:61], s[0:1], 48
    s_load_dwordx2 s[64:65], s[0:1], 56
    s_load_dwordx2 s[68:69], s[0:1], 64
    s_load_dwordx2 s[72:73], s[0:1], 72
    s_cmp_ge_u32 s5, 16
    s_cbranch_scc1 L_F
L_W:
    s_lshl_b32 s19, s5, 17
    s_lshl_b32 s20, s6, 15
    s_add_u32 s19, s19, s20
    s_lshl_b32 s20, s4, 10
    s_add_u32 s19, s19, s20
    s_mov_b32 m0, 114688
    s_nop 0
    buffer_load_dwordx4 v2, s[52:55], s19 offen  lds
    s_add_u32 s19, s19, 8192
    buffer_load_dwordx4 v2, s[52:55], s19 offen  lds
    s_add_u32 s19, s19, 8192
    buffer_load_dwordx4 v2, s[52:55], s19 offen  lds
    s_add_u32 s19, s19, 8192
    buffer_load_dwordx4 v2, s[52:55], s19 offen  lds
    s_cmp_lg_u32 s6, 3
    s_cbranch_scc1 L_noclr_1
    v_mov_b32 v232, -1
    v_mov_b32 v233, -1
    v_mov_b32 v234, -1
    v_mov_b32 v235, -1
    v_lshrrev_b32 v236, 2, v1
    v_and_b32 v237, 3, v1
    v_lshlrev_b32 v236, 13, v236
    v_lshl_add_u32 v236, v237, 4, v236
    s_lshl_b32 s19, s4, 10
    s_lshl_b32 s20, s7, 6
    s_add_u32 s19, s19, s20
    s_mov_b32 exec_lo, -1
    s_mov_b32 exec_hi, 15
    buffer_store_dwordx4 v[232:235], v236, s[80:83], s19 offen sc1
    s_mov_b64 exec, -1
L_noclr_1:
    s_cmp_lg_u32 s6, 3
    s_cbranch_scc1 L_noxt_2
    s_waitcnt lgkmcnt(0)
    s_add_u32 s19, s14, 0x1011
    s_and_b32 s19, s19, 0xfffffff0
    s_or_b32 s19, s19, s39
    s_lshl_b32 s20, s4, 7
    s_lshl_b32 s21, s5, 2
    s_add_u32 s20, s20, s21
    s_add_u32 s20, s20, 73728
    v_mov_b32 v237, s19
    v_mov_b32 v238, 0
    s_mov_b64 exec, 1
    buffer_store_dword v237, v238, s[80:83], s20 offen sc1
    s_mov_b64 exec, -1
L_noxt_2:
    s_cmp_lg_u32 s6, 2
    s_cbranch_scc1 L_nopf_3
    s_getpc_b64 s[10:11]
L_pc_4:
    s_sub_u32 s10, s10, L_pc_4-L_W
    s_subb_u32 s11, s11, 0
    v_lshlrev_b32 v238, 6, v1
    v_min_u32 v239, L_F-L_W-4, v238
    global_load_dword v255, v239, s[10:11]
    v_add_u32 v238, 4096, v238
    v_min_u32 v239, L_F-L_W-4, v238
    global_load_dword v255, v239, s[10:11]
    v_add_u32 v238, 4096, v238
    v_min_u32 v239, L_F-L_W-4, v238
    global_load_dword v255, v239, s[10:11]
    v_add_u32 v238, 4096, v238
    v_min_u32 v239, L_F-L_W-4, v238
    global_load_dword v255, v239, s[10:11]
L_nopf_3:
    s_waitcnt vmcnt(0)
    v_lshrrev_b32 v222, 5, v1
    v_and_b32 v223, 3, v1
    v_lshlrev_b32 v222, 1, v222
    v_xor_b32 v222, v222, v223
    v_lshrrev_b32 v223, 2, v1
    v_mul_u32_u24 v223, 8192, v223
    v_lshl_add_u32 v235, v222, 4, v223
    s_lshl_b32 s19, s6, 20
    s_lshl_b32 s20, s4, 10
    s_add_u32 s19, s19, s20
    s_lshl_b32 s20, s7, 6
    s_add_u32 s19, s19, s20
    s_lshl_b32 s20, s6, 13
    s_add_u32 s20, s20, 65536
    s_mov_b32 m0, s20
    s_nop 0
    buffer_load_dwordx4 v235, s[52:55], s19 offen offset:0  lds
    s_add_u32 s19, s19, 130048
    buffer_load_dwordx4 v235, s[52:55], s19 offen offset:1024  lds
    s_add_u32 s19, s19, 130048
    buffer_load_dwordx4 v235, s[52:55], s19 offen offset:2048  lds
    s_add_u32 s19, s19, 130048
    buffer_load_dwordx4 v235, s[52:55], s19 offen offset:3072  lds
    s_add_u32 s19, s19, 134144
    s_add_u32 m0, m0, 4096
    s_nop 0
    s_nop 0
    buffer_load_dwordx4 v235, s[52:55], s19 offen offset:0  lds
    s_add_u32 s19, s19, 130048
    buffer_load_dwordx4 v235, s[52:55], s19 offen offset:1024  lds
    s_add_u32 s19, s19, 130048
    buffer_load_dwordx4 v235, s[52:55], s19 offen offset:2048  lds
    s_add_u32 s19, s19, 130048
    buffer_load_dwordx4 v235, s[52:55], s19 offen offset:3072  lds
    v_and_b32 v225, 3, v1
    v_lshrrev_b32 v223, 4, v1
    v_lshlrev_b32 v224, 4, v223
    s_nop 0
    v_lshl_add_u32 v236, v225, 6, v224
    s_mov_b32 s24, 0x0fff0fff
    s_mov_b32 s25, 0x0fff0fff
    s_mov_b32 exec_lo, 0xf000f000
    s_mov_b32 exec_hi, 0xf000f000
    v_mov_b32 v80, 0x3f803f80
    v_mov_b32 v81, 0x3f803f80
    v_mov_b32 v82, 0x3f803f80
    v_mov_b32 v83, 0x3f803f80
    v_mov_b32 v84, 0x3f803f80
    v_mov_b32 v85, 0x3f803f80
    v_mov_b32 v86, 0x3f803f80
    v_mov_b32 v87, 0x3f803f80
    v_mov_b32 v88, 0x3f803f80
    v_mov_b32 v89, 0x3f803f80
    v_mov_b32 v90, 0x3f803f80
    v_mov_b32 v91, 0x3f803f80
    v_mov_b32 v92, 0x3f803f80
    v_mov_b32 v93, 0x3f803f80
    v_mov_b32 v94, 0x3f803f80
    v_mov_b32 v95, 0x3f803f80
    s_mov_b64 exec, -1
    v_and_b32 v224, 7, v1
    v_lshrrev_b32 v225, 5, v1
    s_lshl_b32 s20, s7, 6
    s_and_b32 s21, s6, 1
    s_lshl_b32 s22, s21, 5
    s_add_u32 s20, s20, s22
    v_lshlrev_b32 v226, 2, v224
    v_add_u32 v129, s20, v226
    v_lshl_add_u32 v237, v225, 1, v129
    buffer_load_dwordx4 v[112:115], v2, s[40:43], 0 offen
    s_mov_b64 exec, s[24:25]
    buffer_load_dwordx4 v[80:83], v236, s[40:43], 0 offen offset:0
    buffer_load_dwordx4 v[84:87], v236, s[40:43], 0 offen offset:256
    buffer_load_dwordx4 v[88:91], v236, s[40:43], 0 offen offset:512
    buffer_load_dwordx4 v[92:95], v236, s[40:43], 0 offen offset:768
    s_mov_b64 exec, -1
    buffer_load_ushort v125, v237, s[40:43], 0 offen
    s_lshr_b32 s20, s7, 2
    s_lshl_b32 s20, s20, 8
    s_and_b32 s22, s7, 3
    s_lshl_b32 s22, s22, 4
    s_add_u32 s20, s20, s22
    s_lshl_b32 s22, s21, 7
    s_add_u32 s20, s20, s22
    v_lshrrev_b32 v226, 2, v224
    v_and_b32 v227, 3, v224
    v_lshlrev_b32 v226, 6, v226
    v_lshl_add_u32 v226, v227, 2, v226
    v_add_u32 v13, s20, v226
    v_lshl_add_u32 v12, v225, 1, v13
    v_and_b32 v222, 15, v1
    v_lshrrev_b32 v223, 4, v1
    v_lshlrev_b32 v224, 4, v223
    v_and_b32 v225, 3, v222
    v_lshlrev_b32 v226, 4, v225
    v_lshl_add_u32 v3, v223, 6, v226
    v_add_u32 v130, 117632, v2
    s_lshl_b32 s19, s6, 12
    s_lshl_b32 s20, s5, 5
    s_add_u32 s19, s19, s20
    v_lshlrev_b32 v226, 14, v222
    v_lshl_add_u32 v226, v223, 10, v226
    v_add_u32 v5, s19, v226
    s_lshl_b32 s20, s5, 4
    v_lshlrev_b32 v226, 9, v225
    v_add_u32 v8, s20, v226
    s_lshl_b32 s19, s6, 2
    s_add_u32 s19, s19, 115712
    v_lshlrev_b32 v226, 4, v225
    v_add_u32 v117, s19, v226
    v_add_u32 v118, 115712, v226
    v_lshlrev_b32 v227, 6, v225
    v_add_u32 v226, v227, v224
    v_add_u32 v120, 115840, v226
    s_lshl_b32 s19, s6, 8
    v_add_u32 v119, s19, v120
    s_lshl_b32 s19, s6, 4
    s_add_u32 s20, s19, 116864
    v_lshl_add_u32 v228, v223, 2, v227
    v_add_u32 v121, s20, v228
    v_and_b32 v228, 60, v1
    v_add_u32 v228, v228, v227
    v_add_u32 v122, 116864, v228
    s_mov_b32 s8, 0x000f000f
    s_mov_b32 s9, 0x000f000f
    s_mov_b32 s24, 0x0fff0fff
    s_mov_b32 s25, 0x0fff0fff
    s_mov_b32 s35, 0x3e0293ee
    s_mov_b32 s3, 0x42200000
    s_cmp_eq_u32 s6, 3
    s_cselect_b32 s12, 15, 0
    s_mov_b32 s13, 0
    v_mov_b32 v131, 115792
    v_mov_b32 v226, 0
    v_mov_b32 v227, 0
    ds_write_b64 v131, v[226:227]
    s_lshl_b32 s19, s4, 10
    s_add_u32 s26, s19, 8192
    s_add_u32 s29, s19, 16384
    s_add_u32 s31, s19, 32768
    s_add_u32 s32, s19, 49152
    s_add_u32 s34, s19, 65536
    s_lshl_b32 s19, s4, 11
    s_add_u32 s28, s19, 81920
    s_add_u32 s38, s19, 114688
    s_lshl_b32 s19, s4, 16
    s_add_u32 s27, s19, 131072
    s_mov_b32 s30, 1179648
    s_mov_b32 s33, 1703936
    s_mov_b32 s58, 4194304
    s_mov_b32 s59, 0x20000
    s_mov_b32 s62, 1835008
    s_mov_b32 s63, 0x20000
    s_mov_b32 s66, 1835008
    s_mov_b32 s67, 0x20000
    s_mov_b32 s70, 1835008
    s_mov_b32 s71, 0x20000
    s_mov_b32 s74, 1024
    s_mov_b32 s75, 0x20000
    s_mov_b32 s15, 0xfff
    s_waitcnt lgkmcnt(0)
    s_add_u32 s14, s14, 0x1011
    s_and_b32 s19, s14, 0xfff
    v_mov_b32 v127, s19
    s_and_b32 s37, s14, 0xfff0
    s_or_b32 s37, s37, s39
    s_and_b32 s19, s14, 0xfffffff0
    s_or_b32 s19, s19, s39
    v_mov_b32 v134, s14
    v_mov_b32 v135, s19
    v_and_b32 v222, 31, v1
    v_lshrrev_b32 v223, 5, v1
    s_lshl_b32 s19, s7, 12
    s_lshl_b32 s20, s6, 10
    s_add_u32 s19, s19, s20
    v_lshlrev_b32 v224, 5, v222
    v_lshl_add_u32 v224, v223, 4, v224
    v_add_u32 v6, s19, v224
    s_lshr_b32 s19, s7, 2
    s_lshl_b32 s19, s19, 9
    v_lshlrev_b32 v224, 4, v222
    v_add_u32 v7, s19, v224
    s_lshr_b32 s19, s7, 2
    s_lshl_b32 s19, s19, 8
    s_and_b32 s20, s7, 3
    s_lshl_b32 s20, s20, 4
    s_add_u32 s19, s19, s20
    s_lshr_b32 s20, s6, 1
    s_lshl_b32 s20, s20, 6
    s_add_u32 s19, s19, s20
    s_and_b32 s20, s6, 1
    s_lshl_b32 s20, s20, 3
    s_add_u32 s19, s19, s20
    v_lshlrev_b32 v224, 7, v223
    v_bfe_u32 v225, v1, 4, 1
    v_lshl_add_u32 v224, v225, 2, v224
    v_add_u32 v9, s19, v224
    v_lshrrev_b32 v223, 3, v1
    v_and_b32 v224, 7, v1
    s_lshl_b32 s19, s7, 11
    s_and_b32 s21, s6, 1
    s_lshl_b32 s20, s21, 10
    s_add_u32 s19, s19, s20
    s_lshl_b32 s20, s4, 15
    s_add_u32 s20, s20, s19
    v_lshlrev_b32 v226, 7, v223
    v_lshl_add_u32 v226, v224, 3, v226
    v_add_u32 v11, s20, v226
    v_and_b32 v222, 15, v1
    v_lshrrev_b32 v223, 4, v1
    v_lshlrev_b32 v224, 2, v222
    s_lshl_b32 s20, s4, 7
    s_add_u32 s20, s20, s19
    v_lshl_add_u32 v225, v223, 15, v224
    v_add_u32 v10, s20, v225
    s_lshl_b32 s19, s21, 9
    s_and_b32 s20, s7, 3
    s_lshl_b32 s20, s20, 6
    s_add_u32 s19, s19, s20
    s_lshr_b32 s20, s7, 2
    s_lshl_b32 s20, s20, 4
    s_add_u32 s19, s19, s20
    v_lshrrev_b32 v224, 3, v222
    v_and_b32 v225, 7, v222
    v_lshlrev_b32 v224, 8, v224
    v_lshl_add_u32 v224, v225, 1, v224
    v_add_u32 v14, s19, v224
    v_min_u32 v15, 223, v0
    v_lshlrev_b32 v15, 1, v15
    v_lshlrev_b32 v123, 1, v0
    v_add_u32 v123, 117120, v123
    v_and_b32 v224, 3, v222
    v_lshlrev_b32 v224, 6, v224
    v_lshl_add_u32 v224, v223, 4, v224
    v_add_u32 v124, 117120, v224
    s_waitcnt vmcnt(0)
    s_barrier
    v_and_b32 v248, 31, v1
    v_lshlrev_b32 v248, 2, v248
    s_lshl_b32 s20, s4, 7
    s_add_u32 s20, s20, 73728
    buffer_load_dword v249, v248, s[80:83], s20 offen sc1
    s_lshl_b32 s22, s4, 23
    s_lshl_b32 s20, s6, 18
    s_add_u32 s22, s22, s20
    s_lshl_b32 s20, s5, 12
    s_add_u32 s22, s22, s20
    s_add_u32 s22, s22, 7340032
    s_add_u32 s23, s22, 131072
    s_lshl_b32 s21, s6, 13
    v_lshrrev_b32 v222, 4, v1
    v_and_b32 v224, 15, v1
    v_lshlrev_b32 v223, 1, v222
    v_lshlrev_b32 v225, 8, v222
    v_xor_b32 v223, v223, v224
    v_lshl_add_u32 v226, v223, 4, v225
    v_xor_b32 v227, 128, v226
    s_add_u32 m0, s21, 0
    s_nop 0
    buffer_load_dwordx4 v226, s[48:51], s22 offen offset:0 nt lds
    buffer_load_dwordx4 v227, s[48:51], s22 offen offset:1024 nt lds
    buffer_load_dwordx4 v226, s[48:51], s22 offen offset:2048 nt lds
    buffer_load_dwordx4 v227, s[48:51], s22 offen offset:3072 nt lds
    s_add_u32 m0, s21, 4096
    s_nop 0
    buffer_load_dwordx4 v226, s[48:51], s23 offen offset:0 nt lds
    buffer_load_dwordx4 v227, s[48:51], s23 offen offset:1024 nt lds
    buffer_load_dwordx4 v226, s[48:51], s23 offen offset:2048 nt lds
    buffer_load_dwordx4 v227, s[48:51], s23 offen offset:3072 nt lds
    s_cmp_ge_u32 s6, 2
    s_cbranch_scc1 L_wB0_5
    v_lshrrev_b32 v222, 4, v1
    v_lshlrev_b32 v223, 9, v222
    v_xor_b32 v222, s6, v222
    v_and_b32 v222, 1, v222
    v_lshl_add_u32 v223, v222, 5, v223
    v_and_b32 v222, 12, v1
    v_lshl_add_u32 v223, v222, 4, v223
    v_and_b32 v222, 3, v1
    s_nop 0
    v_lshl_add_u32 v223, v222, 3, v223
    v_add_u32 v224, 65536, v223
    ds_read_b64_tr_b16 a[0:1], v224 offset:0
    ds_read_b64_tr_b16 a[2:3], v224 offset:256
    ds_read_b64_tr_b16 a[4:5], v224 offset:2048
    ds_read_b64_tr_b16 a[6:7], v224 offset:2304
    ds_read_b64_tr_b16 a[8:9], v224 offset:4096
    ds_read_b64_tr_b16 a[10:11], v224 offset:4352
    ds_read_b64_tr_b16 a[12:13], v224 offset:6144
    ds_read_b64_tr_b16 a[14:15], v224 offset:6400
    ds_read_b64_tr_b16 a[16:17], v224 offset:8192
    ds_read_b64_tr_b16 a[18:19], v224 offset:8448
    ds_read_b64_tr_b16 a[20:21], v224 offset:10240
    ds_read_b64_tr_b16 a[22:23], v224 offset:10496
    ds_read_b64_tr_b16 a[24:25], v224 offset:12288
    ds_read_b64_tr_b16 a[26:27], v224 offset:12544
    ds_read_b64_tr_b16 a[28:29], v224 offset:14336
    ds_read_b64_tr_b16 a[30:31], v224 offset:14592
    ds_read_b64_tr_b16 a[32:33], v224 offset:16384
    ds_read_b64_tr_b16 a[34:35], v224 offset:16640
    ds_read_b64_tr_b16 a[36:37], v224 offset:18432
    ds_read_b64_tr_b16 a[38:39], v224 offset:18688
    ds_read_b64_tr_b16 a[40:41], v224 offset:20480
    ds_read_b64_tr_b16 a[42:43], v224 offset:20736
    ds_read_b64_tr_b16 a[44:45], v224 offset:22528
    ds_read_b64_tr_b16 a[46:47], v224 offset:22784
    ds_read_b64_tr_b16 a[48:49], v224 offset:24576
    ds_read_b64_tr_b16 a[50:51], v224 offset:24832
    ds_read_b64_tr_b16 a[52:53], v224 offset:26624
    ds_read_b64_tr_b16 a[54:55], v224 offset:26880
    ds_read_b64_tr_b16 a[56:57], v224 offset:28672
    ds_read_b64_tr_b16 a[58:59], v224 offset:28928
    ds_read_b64_tr_b16 a[60:61], v224 offset:30720
    ds_read_b64_tr_b16 a[62:63], v224 offset:30976
    s_waitcnt lgkmcnt(0)
    s_waitcnt vmcnt(8)
    s_and_b32 s19, s14, 0xfffffff0
    s_or_b32 s19, s19, s39
    v_cmp_ne_u32 vcc, s19, v249
    s_cmp_eq_u64 vcc, 0
    s_cselect_b32 s17, 1, 0
    s_nop 0
    v_mov_b32 v175, 0x3f803f80
    v_mfma_f32_16x16x32_bf16 v[140:143], v[80:83], a[0:3], 0
    v_dot2_f32_bf16 v172, v112, v175, 0
    v_dot2_f32_bf16 v173, v112, v112, 0
    v_mfma_f32_16x16x32_bf16 v[144:147], v[80:83], a[4:7], 0
    v_dot2_f32_bf16 v172, v113, v175, v172
    v_dot2_f32_bf16 v173, v113, v113, v173
    v_mfma_f32_16x16x32_bf16 v[148:151], v[80:83], a[8:11], 0
    v_dot2_f32_bf16 v172, v114, v175, v172
    v_dot2_f32_bf16 v173, v114, v114, v173
    v_mfma_f32_16x16x32_bf16 v[152:155], v[80:83], a[12:15], 0
    v_dot2_f32_bf16 v172, v115, v175, v172
    v_dot2_f32_bf16 v173, v115, v115, v173
    v_mfma_f32_16x16x32_bf16 v[140:143], v[84:87], a[16:19], v[140:143]
    s_nop 1
    v_permlane32_swap_b32 v172, v173
    v_mfma_f32_16x16x32_bf16 v[144:147], v[84:87], a[20:23], v[144:147]
    v_add_f32 v172, v172, v173
    v_mov_b32 v174, v172
    v_mfma_f32_16x16x32_bf16 v[148:151], v[84:87], a[24:27], v[148:151]
    s_nop 0
    v_permlane16_swap_b32 v172, v174
    v_mfma_f32_16x16x32_bf16 v[152:155], v[84:87], a[28:31], v[152:155]
    v_add_f32 v172, v172, v174
    s_nop 0
    v_mfma_f32_16x16x32_bf16 v[140:143], v[88:91], a[32:35], v[140:143]
    v_add_f32_dpp v172, v172, v172 row_ror:8 row_mask:0xf bank_mask:0xf
    s_nop 0
    v_mfma_f32_16x16x32_bf16 v[144:147], v[88:91], a[36:39], v[144:147]
    v_add_f32_dpp v172, v172, v172 row_ror:4 row_mask:0xf bank_mask:0xf
    s_nop 0
    v_mfma_f32_16x16x32_bf16 v[148:151], v[88:91], a[40:43], v[148:151]
    v_add_f32_dpp v172, v172, v172 row_ror:2 row_mask:0xf bank_mask:0xf
    s_nop 0
    v_mfma_f32_16x16x32_bf16 v[152:155], v[88:91], a[44:47], v[152:155]
    v_add_f32_dpp v172, v172, v172 row_ror:1 row_mask:0xf bank_mask:0xf
    v_mov_b32 v173, v172
    v_mfma_f32_16x16x32_bf16 v[140:143], v[92:95], a[48:51], v[140:143]
    s_nop 0
    v_permlane32_swap_b32 v172, v173
    v_mfma_f32_16x16x32_bf16 v[144:147], v[92:95], a[52:55], v[144:147]
    v_mul_f32 v172, 0x3b000000, v172
    v_mul_f32 v173, 0x3b000000, v173
    v_mfma_f32_16x16x32_bf16 v[148:151], v[92:95], a[56:59], v[148:151]
    v_fma_f32 v173, -v172, v172, v173
    v_max_f32 v173, 0, v173
    v_mfma_f32_16x16x32_bf16 v[152:155], v[92:95], a[60:63], v[152:155]
    v_add_f32 v173, 0x3727c5ac, v173
    v_rsq_f32 v173, v173
    v_add_f32 v176, v140, v145
    s_nop 4
    v_add_f32 v177, v150, v155
    v_add_f32 v176, v176, v177
    v_mov_b32 v177, v176
    v_mov_b32 v178, v176
    s_nop 1
    v_permlane32_swap_b32 v177, v178
    v_mov_b32 v116, v178
    s_nop 1
    v_permlane16_swap_b32 v178, v116
    v_fma_f32 v176, -v172, v116, v176
    v_mul_f32 v176, v173, v176
    v_cvt_pk_bf16_f32 v176, v176, v176
    v_mov_b32 v177, s37
    v_and_b32 v176, 0xffff0000, v176
    v_or_b32 v176, v176, v177
    v_lshlrev_b32 v178, 1, v14
    s_mov_b64 exec, 0xffff
    s_cmp_eq_u32 s17, 0
    s_cbranch_scc1 L_slow_6
    buffer_store_dword v176, v178, s[80:83], s38 offen
L_pubd_7:
    s_mov_b64 exec, -1
    s_barrier
    s_lshl_b32 s22, s4, 23
    s_lshl_b32 s20, s6, 18
    s_add_u32 s22, s22, s20
    s_lshl_b32 s20, s5, 12
    s_add_u32 s22, s22, s20
    s_add_u32 s22, s22, 7340032
    s_add_u32 s23, s22, 131072
    s_lshl_b32 s21, s6, 13
    v_lshrrev_b32 v222, 4, v1
    v_and_b32 v224, 15, v1
    v_lshlrev_b32 v225, 8, v222
    v_xor_b32 v223, v222, v224
    v_lshl_add_u32 v228, v223, 4, v225
    v_xor_b32 v229, 64, v228
    v_xor_b32 v230, 128, v228
    v_xor_b32 v231, 192, v228
    s_add_u32 m0, s21, 32768
    s_nop 0
    buffer_load_dwordx4 v228, s[44:47], s22 offen offset:0 nt lds
    buffer_load_dwordx4 v229, s[44:47], s22 offen offset:1024 nt lds
    buffer_load_dwordx4 v230, s[44:47], s22 offen offset:2048 nt lds
    buffer_load_dwordx4 v231, s[44:47], s22 offen offset:3072 nt lds
    s_add_u32 m0, s21, 36864
    s_nop 0
    buffer_load_dwordx4 v228, s[44:47], s23 offen offset:0 nt lds
    buffer_load_dwordx4 v229, s[44:47], s23 offen offset:1024 nt lds
    buffer_load_dwordx4 v230, s[44:47], s23 offen offset:2048 nt lds
    buffer_load_dwordx4 v231, s[44:47], s23 offen offset:3072 nt lds
L_wfq_8:
    v_lshlrev_b32 v238, 5, v1
    s_waitcnt vmcnt(8)
    s_barrier
    s_cmp_lg_u32 s6, 0
    s_cbranch_scc1 L_fq_n0_10
    buffer_load_dwordx4 v[224:227], v238, s[80:83], s38 offen sc1
    buffer_load_dwordx4 v[228:231], v238, s[80:83], s38 offen offset:16 sc1
L_fq_n0_10:
    v_lshrrev_b32 v222, 4, v1
    v_bfe_u32 v223, v1, 2, 2
    v_lshl_add_u32 v222, v222, 2, v223
    v_and_b32 v223, 7, v222
    s_lshl_b32 s19, s6, 1
    v_xor_b32 v223, s19, v223
    v_lshlrev_b32 v223, 5, v223
    v_lshl_add_u32 v222, v222, 8, v223
    v_and_b32 v223, 3, v1
    v_lshl_add_u32 v222, v223, 3, v222
    v_xor_b32 v223, 32, v222
    ds_read_b64_tr_b16 v[48:49], v222 offset:0
    ds_read_b64_tr_b16 v[50:51], v222 offset:4096
    ds_read_b64_tr_b16 v[52:53], v222 offset:8192
    ds_read_b64_tr_b16 v[54:55], v222 offset:12288
    ds_read_b64_tr_b16 v[56:57], v222 offset:16384
    ds_read_b64_tr_b16 v[58:59], v222 offset:20480
    ds_read_b64_tr_b16 v[60:61], v222 offset:24576
    ds_read_b64_tr_b16 v[62:63], v222 offset:28672
    ds_read_b64_tr_b16 v[64:65], v223 offset:0
    ds_read_b64_tr_b16 v[66:67], v223 offset:4096
    ds_read_b64_tr_b16 v[68:69], v223 offset:8192
    ds_read_b64_tr_b16 v[70:71], v223 offset:12288
    ds_read_b64_tr_b16 v[72:73], v223 offset:16384
    ds_read_b64_tr_b16 v[74:75], v223 offset:20480
    ds_read_b64_tr_b16 v[76:77], v223 offset:24576
    ds_read_b64_tr_b16 v[78:79], v223 offset:28672
    s_cmp_lg_u32 s6, 0
    s_cbranch_scc1 L_fq_k_11
    s_waitcnt vmcnt(2)
    s_branch L_fq_k2_12
L_fq_k_11:
    s_waitcnt vmcnt(0)
L_fq_k2_12:
    s_cmp_lg_u32 s6, 0
    s_cbranch_scc1 L_fq_b1_9
    s_mov_b32 s18, 60000
    v_mov_b32 v221, s37
L_q0_13:
    s_waitcnt vmcnt(0)
    v_bitop3_b32 v216, v224, v225, v221 bitop3:0x7e
    v_bitop3_b32 v217, v226, v227, v221 bitop3:0x7e
    v_bitop3_b32 v218, v228, v229, v221 bitop3:0x7e
    v_bitop3_b32 v219, v230, v231, v221 bitop3:0x7e
    v_or3_b32 v216, v216, v217, v218
    v_or_b32 v216, v216, v219
    v_and_b32 v217, 0xfff0, v216
    v_cmp_ne_u32 vcc, 0, v217
    s_cbranch_vccz L_q0ok_14
    s_sleep 2
    buffer_load_dwordx4 v[224:227], v238, s[80:83], s38 offen sc1
    buffer_load_dwordx4 v[228:231], v238, s[80:83], s38 offen offset:16 sc1
    s_sub_u32 s18, s18, 1
    s_cbranch_scc1 L_bail
    s_branch L_q0_13
L_q0ok_14:
    v_and_b32 v217, 15, v216
    v_cmp_ne_u32 vcc, 0, v217
    s_mov_b32 s19, 0x07060302
    v_perm_b32 v136, v225, v224, s19
    v_perm_b32 v137, v227, v226, s19
    v_perm_b32 v138, v229, v228, s19
    v_perm_b32 v139, v231, v230, s19
    s_cmp_eq_u64 vcc, 0
    s_cselect_b32 s20, 1, 0
    ds_write_b128 v130, v[136:139]
    v_mov_b32 v216, s20
    v_mov_b32 v217, 115776
    ds_write_b32 v217, v216
L_fq_b1_9:
    v_and_b32 v232, 15, v1
    v_lshrrev_b32 v233, 4, v1
    v_xor_b32 v233, v233, v232
    v_lshlrev_b32 v233, 4, v233
    v_lshl_add_u32 v232, v232, 8, v233
    s_lshl_b32 s19, s6, 13
    v_add_u32 v232, s19, v232
    v_xor_b32 v233, 64, v232
    v_xor_b32 v234, 128, v232
    v_xor_b32 v235, 192, v232
    ds_read_b128 v[16:19], v232 offset:32768
    ds_read_b128 v[20:23], v233 offset:32768
    ds_read_b128 v[24:27], v234 offset:32768
    ds_read_b128 v[28:31], v235 offset:32768
    ds_read_b128 v[32:35], v232 offset:36864
    ds_read_b128 v[36:39], v233 offset:36864
    ds_read_b128 v[40:43], v234 offset:36864
    ds_read_b128 v[44:47], v235 offset:36864
    s_waitcnt lgkmcnt(0)
    s_barrier
    v_mov_b32 v217, 115776
    ds_read_b128 v[136:139], v130
    ds_read_b32 v216, v217
    s_waitcnt lgkmcnt(0)
    v_readfirstlane_b32 s16, v216
    v_mfma_f32_16x16x32_bf16 v[180:183], v[16:19], v[136:139], 0
    v_mov_b32_dpp v140, v136 row_ror:12 row_mask:0xf bank_mask:0xf
    v_mov_b32_dpp v141, v137 row_ror:12 row_mask:0xf bank_mask:0xf
    v_mov_b32_dpp v142, v138 row_ror:12 row_mask:0xf bank_mask:0xf
    v_mov_b32_dpp v143, v139 row_ror:12 row_mask:0xf bank_mask:0xf
    v_mfma_f32_16x16x32_bf16 v[184:187], v[32:35], v[136:139], 0
    s_nop 0
    s_nop 0
    v_mfma_f32_16x16x32_bf16 v[180:183], v[20:23], v[140:143], v[180:183]
    v_mov_b32_dpp v144, v136 row_ror:8 row_mask:0xf bank_mask:0xf
    v_mov_b32_dpp v145, v137 row_ror:8 row_mask:0xf bank_mask:0xf
    v_mov_b32_dpp v146, v138 row_ror:8 row_mask:0xf bank_mask:0xf
    v_mov_b32_dpp v147, v139 row_ror:8 row_mask:0xf bank_mask:0xf
    v_mfma_f32_16x16x32_bf16 v[184:187], v[36:39], v[140:143], v[184:187]
    s_nop 0
    s_nop 0
    v_mfma_f32_16x16x32_bf16 v[180:183], v[24:27], v[144:147], v[180:183]
    v_mov_b32_dpp v148, v136 row_ror:4 row_mask:0xf bank_mask:0xf
    v_mov_b32_dpp v149, v137 row_ror:4 row_mask:0xf bank_mask:0xf
    v_mov_b32_dpp v150, v138 row_ror:4 row_mask:0xf bank_mask:0xf
    v_mov_b32_dpp v151, v139 row_ror:4 row_mask:0xf bank_mask:0xf
    v_mfma_f32_16x16x32_bf16 v[184:187], v[40:43], v[144:147], v[184:187]
    s_nop 0
    v_mfma_f32_16x16x32_bf16 v[180:183], v[28:31], v[148:151], v[180:183]
    v_mfma_f32_16x16x32_bf16 v[184:187], v[44:47], v[148:151], v[184:187]
    v_mov_b32 v132, 0
    s_mov_b64 exec, s[8:9]
    s_nop 4
    v_mul_f32 v180, s35, v180
    v_mul_f32 v181, s35, v181
    v_mul_f32 v182, s35, v182
    v_mul_f32 v183, s35, v183
    v_mul_f32 v184, s35, v184
    v_mul_f32 v185, s35, v185
    v_mul_f32 v186, s35, v186
    v_mul_f32 v187, s35, v187
    v_exp_f32 v200, v180
    v_exp_f32 v201, v181
    v_exp_f32 v202, v182
    v_exp_f32 v203, v183
    v_exp_f32 v204, v184
    v_exp_f32 v205, v185
    v_exp_f32 v206, v186
    v_exp_f32 v207, v187
    v_cvt_pk_bf16_f32 v192, v200, v201
    v_cvt_pk_bf16_f32 v193, v202, v203
    v_cvt_pk_bf16_f32 v194, v204, v205
    v_cvt_pk_bf16_f32 v195, v206, v207
    ds_write_b128 v119, v[192:195]
    v_add_f32 v189, v200, v201
    v_add_f32 v196, v202, v203
    v_add_f32 v197, v204, v205
    v_add_f32 v198, v206, v207
    v_max3_f32 v188, |v180|, |v181|, |v182|
    v_add_f32 v189, v189, v196
    v_max3_f32 v190, |v183|, |v184|, |v185|
    v_add_f32 v197, v197, v198
    v_max3_f32 v188, v188, |v186|, |v187|
    v_add_f32 v189, v189, v197
    v_max_f32 v188, v188, v190
    ds_write_b32 v121, v189
    v_cmp_nge_f32 vcc, s3, v188
    s_cbranch_vccnz L_unsafe_17
L_unsafe2_18:
    s_mov_b64 exec, -1
    s_waitcnt lgkmcnt(0)
    s_barrier
    s_nop 0
    ds_read_b128 v[208:211], v120 offset:0
    ds_read_b128 v[212:215], v120 offset:256
    ds_read_b128 v[216:219], v120 offset:512
    ds_read_b128 v[220:223], v120 offset:768
    ds_read_b32 v190, v122
    ds_read_b32 v191, v131 offset:0
    s_waitcnt lgkmcnt(0)
    v_cmp_ne_u32 vcc, 0, v191
    s_cbranch_vccnz L_smax_15
L_sback_16:
    v_mfma_f32_16x16x32_bf16 v[240:243], v[48:51], v[208:211], 0
    v_add_f32_dpp v190, v190, v190 row_ror:4 row_mask:0xf bank_mask:0xf
    s_nop 1
    v_mfma_f32_16x16x32_bf16 v[244:247], v[64:67], v[208:211], 0
    v_add_f32_dpp v190, v190, v190 row_ror:8 row_mask:0xf bank_mask:0xf
    v_mov_b32 v191, v190
    v_mfma_f32_16x16x32_bf16 v[240:243], v[52:55], v[212:215], v[240:243]
    s_nop 0
    v_permlane16_swap_b32 v190, v191
    v_mfma_f32_16x16x32_bf16 v[244:247], v[68:71], v[212:215], v[244:247]
    v_add_f32 v190, v190, v191
    v_mov_b32 v191, v190
    v_mfma_f32_16x16x32_bf16 v[240:243], v[56:59], v[216:219], v[240:243]
    s_nop 0
    v_permlane32_swap_b32 v190, v191
    v_mfma_f32_16x16x32_bf16 v[244:247], v[72:75], v[216:219], v[244:247]
    v_add_f32 v133, v190, v191
    v_mfma_f32_16x16x32_bf16 v[240:243], v[60:63], v[220:223], v[240:243]
    v_mfma_f32_16x16x32_bf16 v[244:247], v[76:79], v[220:223], v[244:247]
    s_nop 6
    s_nop 0
    v_bfi_b32 v240, s15, v127, v240
    v_bfi_b32 v241, s15, v127, v241
    v_bfi_b32 v242, s15, v127, v242
    v_bfi_b32 v243, s15, v127, v243
    v_bfi_b32 v244, s15, v127, v244
    v_bfi_b32 v245, s15, v127, v245
    v_bfi_b32 v246, s15, v127, v246
    v_bfi_b32 v247, s15, v127, v247
    s_mov_b64 exec, s[12:13]
    s_cmp_eq_u32 s16, 0
    s_cbranch_scc1 L_slow_19
    buffer_store_dwordx4 v[132:135], v8, s[80:83], s28 offen
    s_mov_b64 exec, s[8:9]
    buffer_store_dwordx4 v[240:243], v5, s[80:83], s27 offen
    buffer_store_dwordx4 v[244:247], v5, s[80:83], s27 offen offset:16
L_pubd_20:
    s_mov_b64 exec, -1
    s_mov_b32 s18, 60000
L_poll_rs_21:
    buffer_load_dwordx4 v[164:167], v6, s[80:83], s27 offen sc1
    buffer_load_dwordx4 v[168:171], v7, s[80:83], s28 offen sc1
    s_sub_u32 s18, s18, 1
    s_cbranch_scc1 L_bail
    s_waitcnt vmcnt(0)
    v_bitop3_b32 v220, v164, v165, v127 bitop3:0x7e
    v_bitop3_b32 v221, v166, v167, v127 bitop3:0x7e
    v_bitop3_b32 v220, v220, v221, s15 bitop3:0xa8
    v_xor_b32 v221, s14, v170
    v_bitop3_b32 v222, v171, s14, -16 bitop3:0x28
    v_or3_b32 v220, v220, v221, v222
    v_cmp_ne_u32 vcc, 0, v220
    s_cbranch_vccnz L_poll_rs_21
    v_lshrrev_b32 v222, 5, v1
    v_and_b32 v223, 3, v1
    v_lshlrev_b32 v222, 1, v222
    v_xor_b32 v222, v222, v223
    v_lshrrev_b32 v223, 2, v1
    v_mul_u32_u24 v223, 1024, v223
    v_lshl_add_u32 v235, v222, 4, v223
    s_lshl_b32 s19, s4, 19
    s_lshl_b32 s20, s6, 17
    s_add_u32 s19, s19, s20
    s_lshl_b32 s20, s7, 6
    s_add_u32 s19, s19, s20
    s_lshl_b32 s20, s6, 13
    s_add_u32 s20, s20, 65536
    s_mov_b32 m0, s20
    s_nop 0
    buffer_load_dwordx4 v235, s[56:59], s19 offen offset:0 nt lds
    s_add_u32 s19, s19, 15360
    buffer_load_dwordx4 v235, s[56:59], s19 offen offset:1024 nt lds
    s_add_u32 s19, s19, 15360
    buffer_load_dwordx4 v235, s[56:59], s19 offen offset:2048 nt lds
    s_add_u32 s19, s19, 15360
    buffer_load_dwordx4 v235, s[56:59], s19 offen offset:3072 nt lds
    s_add_u32 s19, s19, 19456
    s_add_u32 m0, m0, 4096
    s_nop 0
    s_nop 0
    buffer_load_dwordx4 v235, s[56:59], s19 offen offset:0 nt lds
    s_add_u32 s19, s19, 15360
    buffer_load_dwordx4 v235, s[56:59], s19 offen offset:1024 nt lds
    s_add_u32 s19, s19, 15360
    buffer_load_dwordx4 v235, s[56:59], s19 offen offset:2048 nt lds
    s_add_u32 s19, s19, 15360
    buffer_load_dwordx4 v235, s[56:59], s19 offen offset:3072 nt lds
    v_cmp_ne_u32 vcc, 0, v168
    v_and_b32 v164, 0xfffff000, v164
    v_and_b32 v165, 0xfffff000, v165
    v_and_b32 v166, 0xfffff000, v166
    v_and_b32 v167, 0xfffff000, v167
    v_mov_b32 v175, v169
    s_cbranch_vccnz L_s3max_22
L_s3back_23:
    v_permlane16_swap_b32 v164, v166
    v_permlane16_swap_b32 v165, v167
    v_mov_b32 v173, v175
    v_add_f32 v164, v164, v166
    v_add_f32 v165, v165, v167
    v_permlane16_swap_b32 v175, v173
    v_add_f32 v175, v175, v173
    s_nop 1
    s_nop 0
    v_add_f32_dpp v175, v175, v175 row_ror:8 row_mask:0xf bank_mask:0xf
    v_add_f32_dpp v164, v164, v164 row_ror:8 row_mask:0xf bank_mask:0xf
    v_add_f32_dpp v165, v165, v165 row_ror:8 row_mask:0xf bank_mask:0xf
    v_add_f32_dpp v175, v175, v175 row_ror:4 row_mask:0xf bank_mask:0xf
    v_add_f32_dpp v164, v164, v164 row_ror:4 row_mask:0xf bank_mask:0xf
    v_add_f32_dpp v165, v165, v165 row_ror:4 row_mask:0xf bank_mask:0xf
    v_add_f32_dpp v175, v175, v175 row_ror:2 row_mask:0xf bank_mask:0xf
    v_add_f32_dpp v164, v164, v164 row_ror:2 row_mask:0xf bank_mask:0xf
    v_add_f32_dpp v165, v165, v165 row_ror:2 row_mask:0xf bank_mask:0xf
    v_add_f32_dpp v175, v175, v175 row_ror:1 row_mask:0xf bank_mask:0xf
    v_add_f32_dpp v164, v164, v164 row_ror:1 row_mask:0xf bank_mask:0xf
    v_add_f32_dpp v165, v165, v165 row_ror:1 row_mask:0xf bank_mask:0xf
    v_rcp_f32 v175, v175
    s_nop 0
    v_mul_f32 v164, v175, v164
    v_mul_f32 v165, v175, v165
    v_cvt_pk_bf16_f32 v164, v164, v165
    s_mov_b32 exec_lo, 0x00010001
    s_mov_b32 exec_hi, 0x00010001
    s_cmp_eq_u32 s16, 0
    s_cbranch_scc1 L_slow_24
    buffer_store_dword v164, v9, s[80:83], s29 offen
L_pubd_25:
    s_mov_b64 exec, -1
    s_add_u32 s27, s27, 524288
    s_add_u32 s28, s28, 16384
    v_and_b32 v220, 15, v171
    v_cmp_ne_u32 vcc, s39, v220
    s_cmp_eq_u64 vcc, 0
    s_cselect_b32 s36, 1, 0
    s_waitcnt vmcnt(0)
    s_barrier
    s_cmp_ge_u32 s6, 2
    s_cbranch_scc1 L_w_b5_26
    s_mov_b32 s18, 60000
    buffer_load_dwordx4 v[96:99], v3, s[80:83], s29 offen offset:0 sc1
    buffer_load_dwordx4 v[100:103], v3, s[80:83], s29 offen offset:256 sc1
    buffer_load_dwordx4 v[104:107], v3, s[80:83], s29 offen offset:512 sc1
    buffer_load_dwordx4 v[108:111], v3, s[80:83], s29 offen offset:768 sc1
    v_lshrrev_b32 v222, 4, v1
    v_lshlrev_b32 v223, 9, v222
    v_xor_b32 v222, s6, v222
    v_and_b32 v222, 1, v222
    v_lshl_add_u32 v223, v222, 5, v223
    v_and_b32 v222, 12, v1
    v_lshl_add_u32 v223, v222, 4, v223
    v_and_b32 v222, 3, v1
    s_nop 0
    v_lshl_add_u32 v223, v222, 3, v223
    v_add_u32 v224, 65536, v223
    ds_read_b64_tr_b16 a[64:65], v224 offset:0
    ds_read_b64_tr_b16 a[66:67], v224 offset:256
    ds_read_b64_tr_b16 a[68:69], v224 offset:2048
    ds_read_b64_tr_b16 a[70:71], v224 offset:2304
    ds_read_b64_tr_b16 a[72:73], v224 offset:4096
    ds_read_b64_tr_b16 a[74:75], v224 offset:4352
    ds_read_b64_tr_b16 a[76:77], v224 offset:6144
    ds_read_b64_tr_b16 a[78:79], v224 offset:6400
    ds_read_b64_tr_b16 a[80:81], v224 offset:8192
    ds_read_b64_tr_b16 a[82:83], v224 offset:8448
    ds_read_b64_tr_b16 a[84:85], v224 offset:10240
    ds_read_b64_tr_b16 a[86:87], v224 offset:10496
    ds_read_b64_tr_b16 a[88:89], v224 offset:12288
    ds_read_b64_tr_b16 a[90:91], v224 offset:12544
    ds_read_b64_tr_b16 a[92:93], v224 offset:14336
    ds_read_b64_tr_b16 a[94:95], v224 offset:14592
    ds_read_b64_tr_b16 a[96:97], v224 offset:16384
    ds_read_b64_tr_b16 a[98:99], v224 offset:16640
    ds_read_b64_tr_b16 a[100:101], v224 offset:18432
    ds_read_b64_tr_b16 a[102:103], v224 offset:18688
    ds_read_b64_tr_b16 a[104:105], v224 offset:20480
    ds_read_b64_tr_b16 a[106:107], v224 offset:20736
    ds_read_b64_tr_b16 a[108:109], v224 offset:22528
    ds_read_b64_tr_b16 a[110:111], v224 offset:22784
    ds_read_b64_tr_b16 a[112:113], v224 offset:24576
    ds_read_b64_tr_b16 a[114:115], v224 offset:24832
    ds_read_b64_tr_b16 a[116:117], v224 offset:26624
    ds_read_b64_tr_b16 a[118:119], v224 offset:26880
    ds_read_b64_tr_b16 a[120:121], v224 offset:28672
    ds_read_b64_tr_b16 a[122:123], v224 offset:28928
    ds_read_b64_tr_b16 a[124:125], v224 offset:30720
    ds_read_b64_tr_b16 a[126:127], v224 offset:30976
    s_waitcnt lgkmcnt(0)
    s_branch L_pchk_28
L_poll_o_27:
    buffer_load_dwordx4 v[96:99], v3, s[80:83], s29 offen offset:0 sc1
    buffer_load_dwordx4 v[100:103], v3, s[80:83], s29 offen offset:256 sc1
    buffer_load_dwordx4 v[104:107], v3, s[80:83], s29 offen offset:512 sc1
    buffer_load_dwordx4 v[108:111], v3, s[80:83], s29 offen offset:768 sc1
    s_sub_u32 s18, s18, 1
    s_cbranch_scc1 L_bail
L_pchk_28:
    s_waitcnt vmcnt(0)
    s_nop 0
    v_max3_u32 v224, v96, v97, v98
    v_max3_u32 v225, v99, v100, v101
    v_max3_u32 v226, v102, v103, v104
    v_max3_u32 v227, v105, v106, v107
    v_max3_u32 v224, v224, v108, v109
    v_max3_u32 v225, v225, v110, v111
    v_max3_u32 v224, v224, v226, v227
    v_max_u32 v224, v224, v225
    v_cmp_eq_u32 vcc, -1, v224
    s_cbranch_vccnz L_poll_o_27
    s_nop 0
    v_mfma_f32_16x16x32_bf16 v[140:143], v[96:99], a[64:67], 0
    v_mfma_f32_16x16x32_bf16 v[144:147], v[96:99], a[68:71], 0
    v_mfma_f32_16x16x32_bf16 v[148:151], v[96:99], a[72:75], 0
    v_mfma_f32_16x16x32_bf16 v[152:155], v[96:99], a[76:79], 0
    v_mfma_f32_16x16x32_bf16 v[140:143], v[100:103], a[80:83], v[140:143]
    v_mfma_f32_16x16x32_bf16 v[144:147], v[100:103], a[84:87], v[144:147]
    v_mfma_f32_16x16x32_bf16 v[148:151], v[100:103], a[88:91], v[148:151]
    v_mfma_f32_16x16x32_bf16 v[152:155], v[100:103], a[92:95], v[152:155]
    v_mfma_f32_16x16x32_bf16 v[140:143], v[104:107], a[96:99], v[140:143]
    v_mfma_f32_16x16x32_bf16 v[144:147], v[104:107], a[100:103], v[144:147]
    v_mfma_f32_16x16x32_bf16 v[148:151], v[104:107], a[104:107], v[148:151]
    v_mfma_f32_16x16x32_bf16 v[152:155], v[104:107], a[108:111], v[152:155]
    v_mfma_f32_16x16x32_bf16 v[140:143], v[108:111], a[112:115], v[140:143]
    v_mfma_f32_16x16x32_bf16 v[144:147], v[108:111], a[116:119], v[144:147]
    v_mfma_f32_16x16x32_bf16 v[148:151], v[108:111], a[120:123], v[148:151]
    v_mfma_f32_16x16x32_bf16 v[152:155], v[108:111], a[124:127], v[152:155]
    s_nop 5
    v_add_f32 v176, v140, v145
    s_nop 0
    v_add_f32 v177, v150, v155
    v_add_f32 v176, v176, v177
    v_bfi_b32 v176, s15, v127, v176
    buffer_store_dword v176, v10, s[80:83], s30 offen sc1
    s_add_u32 s19, s30, 131072
    buffer_store_dword v176, v10, s[80:83], s19 offen sc1
    s_nop 15
    s_nop 15
    s_nop 15
    s_nop 15
    s_nop 15
    s_nop 15
    s_nop 15
    s_nop 15
    s_mov_b32 s18, 60000
L_poll_c1_29:
    buffer_load_dwordx2 v[164:165], v11, s[80:83], s30 offen sc1
    s_sub_u32 s18, s18, 1
    s_cbranch_scc1 L_bail
    s_waitcnt vmcnt(0)
    v_bitop3_b32 v168, v164, v165, v127 bitop3:0x7e
    v_and_b32 v168, s15, v168
    v_cmp_ne_u32 vcc, 0, v168
    s_cbranch_vccnz L_poll_c1_29
    v_and_b32 v164, 0xfffff000, v164
    v_and_b32 v165, 0xfffff000, v165
    v_lshlrev_b32 v167, 16, v125
    s_nop 0
    v_permlane32_swap_b32 v164, v165
    v_add_f32 v164, v164, v165
    v_mov_b32 v165, v164
    s_nop 1
    v_permlane16_swap_b32 v164, v165
    v_add_f32 v164, v164, v165
    s_nop 1
    v_add_f32_dpp v164, v164, v164 row_ror:8 row_mask:0xf bank_mask:0xf
    v_add_f32 v164, v164, v167
    v_mov_b32 v165, v164
    s_nop 1
    v_permlane32_swap_b32 v164, v165
    v_cvt_pk_bf16_f32 v164, v164, v165
    s_mov_b64 exec, 0xff
    s_cmp_eq_u32 s36, 0
    s_cbranch_scc1 L_slow_30
    buffer_store_dword v164, v13, s[80:83], s31 offen
L_pubd_31:
    s_mov_b64 exec, -1
L_w_b5_26:
    s_add_u32 s29, s29, 8192
    s_add_u32 s30, s30, 262144
    s_barrier
    v_lshrrev_b32 v222, 5, v1
    v_and_b32 v223, 3, v1
    v_lshlrev_b32 v222, 1, v222
    v_xor_b32 v222, v222, v223
    v_lshrrev_b32 v223, 2, v1
    v_mul_u32_u24 v223, 1024, v223
    v_lshl_add_u32 v235, v222, 4, v223
    s_mul_i32 s19, s4, 229376
    s_lshl_b32 s20, s6, 16
    s_add_u32 s19, s19, s20
    s_lshl_b32 s20, s7, 6
    s_add_u32 s19, s19, s20
    s_lshl_b32 s20, s6, 12
    s_add_u32 s20, s20, 98304
    s_cmp_eq_u32 s6, 3
    s_cselect_b32 s21, 0x10000000, 0
    s_mov_b32 m0, s20
    s_nop 0
    buffer_load_dwordx4 v235, s[68:71], s19 offen offset:0 nt lds
    s_add_u32 s19, s19, 15360
    buffer_load_dwordx4 v235, s[68:71], s19 offen offset:1024 nt lds
    s_add_u32 s19, s19, 15360
    s_add_u32 s19, s19, s21
    buffer_load_dwordx4 v235, s[68:71], s19 offen offset:2048 nt lds
    s_add_u32 s19, s19, 15360
    buffer_load_dwordx4 v235, s[68:71], s19 offen offset:3072 nt lds
    s_waitcnt vmcnt(0)
    s_barrier
    s_cmp_ge_u32 s6, 2
    s_cbranch_scc1 L_now2_32
    v_lshrrev_b32 v222, 4, v1
    v_lshlrev_b32 v223, 9, v222
    v_xor_b32 v222, s6, v222
    v_and_b32 v222, 1, v222
    v_lshl_add_u32 v223, v222, 5, v223
    v_and_b32 v222, 12, v1
    v_lshl_add_u32 v223, v222, 4, v223
    v_and_b32 v222, 3, v1
    v_lshl_add_u32 v223, v222, 3, v223
    v_add_u32 v224, 98304, v223
    ds_read_b64_tr_b16 a[128:129], v224 offset:0
    ds_read_b64_tr_b16 a[130:131], v224 offset:256
    ds_read_b64_tr_b16 a[132:133], v224 offset:2048
    ds_read_b64_tr_b16 a[134:135], v224 offset:2304
    ds_read_b64_tr_b16 a[136:137], v224 offset:4096
    ds_read_b64_tr_b16 a[138:139], v224 offset:4352
    ds_read_b64_tr_b16 a[140:141], v224 offset:6144
    ds_read_b64_tr_b16 a[142:143], v224 offset:6400
    ds_read_b64_tr_b16 a[144:145], v224 offset:8192
    ds_read_b64_tr_b16 a[146:147], v224 offset:8448
    ds_read_b64_tr_b16 a[148:149], v224 offset:10240
    ds_read_b64_tr_b16 a[150:151], v224 offset:10496
    ds_read_b64_tr_b16 a[152:153], v224 offset:12288
    ds_read_b64_tr_b16 a[154:155], v224 offset:12544
    s_waitcnt lgkmcnt(0)
L_now2_32:
    s_mov_b32 s18, 60000
L_poll_gu_33:
    buffer_load_ushort v164, v15, s[80:83], s32 offen sc1
    buffer_load_ushort v165, v15, s[80:83], s32 offen offset:512 sc1
    buffer_load_ushort v126, v12, s[80:83], s31 offen sc1
    s_sub_u32 s18, s18, 1
    s_cbranch_scc1 L_bail
    s_waitcnt vmcnt(0)
    v_max3_u32 v166, v164, v165, v126
    v_cmp_eq_u32 vcc, 0xffff, v166
    s_cbranch_vccnz L_poll_gu_33
    v_lshlrev_b32 v164, 16, v164
    v_lshlrev_b32 v165, 16, v165
    v_mul_f32 v166, 0xbfb8aa3b, v164
    v_mul_f32 v164, v164, v165
    v_exp_f32 v166, v166
    s_nop 0
    v_add_f32 v166, 1.0, v166
    v_rcp_f32 v166, v166
    s_nop 0
    v_mul_f32 v164, v164, v166
    v_cvt_pk_bf16_f32 v164, v164, v164
    ds_write_b16 v123, v164
    s_add_u32 s31, s31, 8192
    s_add_u32 s32, s32, 8192
    s_waitcnt lgkmcnt(0)
    s_barrier
    s_cmp_ge_u32 s6, 2
    s_cbranch_scc1 L_W_P1
    ds_read_b128 v[164:167], v124
    ds_read_b128 v[168:171], v124 offset:256
    s_waitcnt lgkmcnt(0)
    s_nop 0
    v_mfma_f32_16x16x32_bf16 v[140:143], v[164:167], a[128:131], 0
    v_mfma_f32_16x16x32_bf16 v[144:147], v[164:167], a[132:135], 0
    v_mfma_f32_16x16x32_bf16 v[148:151], v[164:167], a[136:139], 0
    v_mfma_f32_16x16x32_bf16 v[152:155], v[164:167], a[140:143], 0
    v_mfma_f32_16x16x32_bf16 v[140:143], v[168:171], a[144:147], v[140:143]
    v_mfma_f32_16x16x32_bf16 v[144:147], v[168:171], a[148:151], v[144:147]
    v_mfma_f32_16x16x32_bf16 v[148:151], v[168:171], a[152:155], v[148:151]
    s_nop 5
    v_add_f32 v176, v155, v140
    s_nop 0
    v_add_f32 v177, v145, v150
    v_add_f32 v176, v176, v177
    v_bfi_b32 v176, s15, v127, v176
    buffer_store_dword v176, v10, s[80:83], s33 offen sc1
    s_add_u32 s19, s33, 131072
    buffer_store_dword v176, v10, s[80:83], s19 offen sc1
    s_nop 15
    s_nop 15
    s_nop 15
    s_nop 15
    s_nop 15
    s_nop 15
    s_nop 15
    s_nop 15
    s_mov_b32 s18, 60000
L_poll_c2_34:
    buffer_load_dwordx2 v[164:165], v11, s[80:83], s33 offen sc1
    s_sub_u32 s18, s18, 1
    s_cbranch_scc1 L_bail
    s_waitcnt vmcnt(0)
    v_bitop3_b32 v168, v164, v165, v127 bitop3:0x7e
    v_and_b32 v168, s15, v168
    v_cmp_ne_u32 vcc, 0, v168
    s_cbranch_vccnz L_poll_c2_34
    v_and_b32 v164, 0xfffff000, v164
    v_and_b32 v165, 0xfffff000, v165
    v_lshlrev_b32 v167, 16, v126
    s_nop 0
    v_permlane32_swap_b32 v164, v165
    v_add_f32 v164, v164, v165
    v_mov_b32 v165, v164
    s_nop 1
    v_permlane16_swap_b32 v164, v165
    v_add_f32 v164, v164, v165
    s_nop 1
    v_add_f32_dpp v164, v164, v164 row_ror:8 row_mask:0xf bank_mask:0xf
    v_add_f32 v164, v164, v167
    v_mov_b32 v165, v164
    s_nop 1
    v_permlane32_swap_b32 v164, v165
    v_cvt_pk_bf16_f32 v164, v164, v165
    s_mov_b64 exec, 0xff
    s_cmp_eq_u32 s16, 0
    s_cbranch_scc1 L_slow_35
    buffer_store_dword v164, v13, s[80:83], s34 offen
L_pubd_36:
    s_mov_b64 exec, -1
    s_add_u32 s33, s33, 262144
L_W_P1:
    s_cmp_ge_u32 s6, 2
    s_cbranch_scc1 L_wq1_37
    s_mov_b32 s18, 60000
L_poll_x2_38:
    buffer_load_dwordx4 v[112:115], v2, s[80:83], s34 offen sc1
    buffer_load_dwordx4 v[80:83], v3, s[80:83], s34 offen offset:0 sc1
    buffer_load_dwordx4 v[84:87], v3, s[80:83], s34 offen offset:256 sc1
    buffer_load_dwordx4 v[88:91], v3, s[80:83], s34 offen offset:512 sc1
    buffer_load_dwordx4 v[92:95], v3, s[80:83], s34 offen offset:768 sc1
    s_sub_u32 s18, s18, 1
    s_cbranch_scc1 L_bail
    s_waitcnt vmcnt(0)
    v_max3_u32 v220, v112, v113, v114
    v_max_u32 v220, v220, v115
    v_cmp_eq_u32 vcc, -1, v220
    s_cbranch_vccnz L_poll_x2_38
    s_nop 0
    buffer_load_ushort v125, v12, s[80:83], s34 offen sc1
    v_mov_b32 v175, 0x3f803f80
    v_mfma_f32_16x16x32_bf16 v[140:143], v[80:83], a[0:3], 0
    v_dot2_f32_bf16 v172, v112, v175, 0
    v_dot2_f32_bf16 v173, v112, v112, 0
    v_mfma_f32_16x16x32_bf16 v[144:147], v[80:83], a[4:7], 0
    v_dot2_f32_bf16 v172, v113, v175, v172
    v_dot2_f32_bf16 v173, v113, v113, v173
    v_mfma_f32_16x16x32_bf16 v[148:151], v[80:83], a[8:11], 0
    v_dot2_f32_bf16 v172, v114, v175, v172
    v_dot2_f32_bf16 v173, v114, v114, v173
    v_mfma_f32_16x16x32_bf16 v[152:155], v[80:83], a[12:15], 0
    v_dot2_f32_bf16 v172, v115, v175, v172
    v_dot2_f32_bf16 v173, v115, v115, v173
    v_mfma_f32_16x16x32_bf16 v[140:143], v[84:87], a[16:19], v[140:143]
    s_nop 1
    v_permlane32_swap_b32 v172, v173
    v_mfma_f32_16x16x32_bf16 v[144:147], v[84:87], a[20:23], v[144:147]
    v_add_f32 v172, v172, v173
    v_mov_b32 v174, v172
    v_mfma_f32_16x16x32_bf16 v[148:151], v[84:87], a[24:27], v[148:151]
    s_nop 0
    v_permlane16_swap_b32 v172, v174
    v_mfma_f32_16x16x32_bf16 v[152:155], v[84:87], a[28:31], v[152:155]
    v_add_f32 v172, v172, v174
    s_nop 0
    v_mfma_f32_16x16x32_bf16 v[140:143], v[88:91], a[32:35], v[140:143]
    v_add_f32_dpp v172, v172, v172 row_ror:8 row_mask:0xf bank_mask:0xf
    s_nop 0
    v_mfma_f32_16x16x32_bf16 v[144:147], v[88:91], a[36:39], v[144:147]
    v_add_f32_dpp v172, v172, v172 row_ror:4 row_mask:0xf bank_mask:0xf
    s_nop 0
    v_mfma_f32_16x16x32_bf16 v[148:151], v[88:91], a[40:43], v[148:151]
    v_add_f32_dpp v172, v172, v172 row_ror:2 row_mask:0xf bank_mask:0xf
    s_nop 0
    v_mfma_f32_16x16x32_bf16 v[152:155], v[88:91], a[44:47], v[152:155]
    v_add_f32_dpp v172, v172, v172 row_ror:1 row_mask:0xf bank_mask:0xf
    v_mov_b32 v173, v172
    v_mfma_f32_16x16x32_bf16 v[140:143], v[92:95], a[48:51], v[140:143]
    s_nop 0
    v_permlane32_swap_b32 v172, v173
    v_mfma_f32_16x16x32_bf16 v[144:147], v[92:95], a[52:55], v[144:147]
    v_mul_f32 v172, 0x3b000000, v172
    v_mul_f32 v173, 0x3b000000, v173
    v_mfma_f32_16x16x32_bf16 v[148:151], v[92:95], a[56:59], v[148:151]
    v_fma_f32 v173, -v172, v172, v173
    v_max_f32 v173, 0, v173
    v_mfma_f32_16x16x32_bf16 v[152:155], v[92:95], a[60:63], v[152:155]
    v_add_f32 v173, 0x3727c5ac, v173
    v_rsq_f32 v173, v173
    v_add_f32 v176, v140, v145
    s_nop 4
    v_add_f32 v177, v150, v155
    v_add_f32 v176, v176, v177
    v_fma_f32 v176, -v172, v116, v176
    v_mul_f32 v176, v173, v176
    s_nop 1
    v_mov_b32_dpp v177, v176 quad_perm:[1,0,3,2] row_mask:0xf bank_mask:0xf
    v_cvt_pk_bf16_f32 v176, v176, v177
    s_mov_b64 exec, 0x5555
    s_cmp_eq_u32 s36, 0
    s_cbranch_scc1 L_slow_39
    buffer_store_dword v176, v14, s[80:83], s26 offen
L_pubd_40:
    s_mov_b64 exec, -1
L_wq1_37:
    s_cmp_lg_u32 s6, 0
    s_cbranch_scc1 L_nq_b1_41
    s_mov_b32 s18, 60000
L_poll_q_42:
    buffer_load_dwordx4 v[136:139], v2, s[80:83], s26 offen sc1
    s_sub_u32 s18, s18, 1
    s_cbranch_scc1 L_bail
    s_waitcnt vmcnt(0)
    v_max3_u32 v220, v136, v137, v138
    v_max_u32 v220, v220, v139
    v_cmp_eq_u32 vcc, -1, v220
    s_cbranch_vccnz L_poll_q_42
    ds_write_b128 v130, v[136:139]
    s_waitcnt lgkmcnt(0)
L_nq_b1_41:
    s_barrier
    ds_read_b128 v[136:139], v130
    s_waitcnt lgkmcnt(0)
    v_mfma_f32_16x16x32_bf16 v[180:183], v[16:19], v[136:139], 0
    v_mov_b32_dpp v140, v136 row_ror:12 row_mask:0xf bank_mask:0xf
    v_mov_b32_dpp v141, v137 row_ror:12 row_mask:0xf bank_mask:0xf
    v_mov_b32_dpp v142, v138 row_ror:12 row_mask:0xf bank_mask:0xf
    v_mov_b32_dpp v143, v139 row_ror:12 row_mask:0xf bank_mask:0xf
    v_mfma_f32_16x16x32_bf16 v[184:187], v[32:35], v[136:139], 0
    s_nop 0
    s_nop 0
    v_mfma_f32_16x16x32_bf16 v[180:183], v[20:23], v[140:143], v[180:183]
    v_mov_b32_dpp v144, v136 row_ror:8 row_mask:0xf bank_mask:0xf
    v_mov_b32_dpp v145, v137 row_ror:8 row_mask:0xf bank_mask:0xf
    v_mov_b32_dpp v146, v138 row_ror:8 row_mask:0xf bank_mask:0xf
    v_mov_b32_dpp v147, v139 row_ror:8 row_mask:0xf bank_mask:0xf
    v_mfma_f32_16x16x32_bf16 v[184:187], v[36:39], v[140:143], v[184:187]
    s_nop 0
    s_nop 0
    v_mfma_f32_16x16x32_bf16 v[180:183], v[24:27], v[144:147], v[180:183]
    v_mov_b32_dpp v148, v136 row_ror:4 row_mask:0xf bank_mask:0xf
    v_mov_b32_dpp v149, v137 row_ror:4 row_mask:0xf bank_mask:0xf
    v_mov_b32_dpp v150, v138 row_ror:4 row_mask:0xf bank_mask:0xf
    v_mov_b32_dpp v151, v139 row_ror:4 row_mask:0xf bank_mask:0xf
    v_mfma_f32_16x16x32_bf16 v[184:187], v[40:43], v[144:147], v[184:187]
    s_nop 0
    v_mfma_f32_16x16x32_bf16 v[180:183], v[28:31], v[148:151], v[180:183]
    v_mfma_f32_16x16x32_bf16 v[184:187], v[44:47], v[148:151], v[184:187]
    v_mov_b32 v132, 0
    s_mov_b64 exec, s[8:9]
    s_nop 4
    v_mul_f32 v180, s35, v180
    v_mul_f32 v181, s35, v181
    v_mul_f32 v182, s35, v182
    v_mul_f32 v183, s35, v183
    v_mul_f32 v184, s35, v184
    v_mul_f32 v185, s35, v185
    v_mul_f32 v186, s35, v186
    v_mul_f32 v187, s35, v187
    v_exp_f32 v200, v180
    v_exp_f32 v201, v181
    v_exp_f32 v202, v182
    v_exp_f32 v203, v183
    v_exp_f32 v204, v184
    v_exp_f32 v205, v185
    v_exp_f32 v206, v186
    v_exp_f32 v207, v187
    v_cvt_pk_bf16_f32 v192, v200, v201
    v_cvt_pk_bf16_f32 v193, v202, v203
    v_cvt_pk_bf16_f32 v194, v204, v205
    v_cvt_pk_bf16_f32 v195, v206, v207
    ds_write_b128 v119, v[192:195]
    v_add_f32 v189, v200, v201
    v_add_f32 v196, v202, v203
    v_add_f32 v197, v204, v205
    v_add_f32 v198, v206, v207
    v_max3_f32 v188, |v180|, |v181|, |v182|
    v_add_f32 v189, v189, v196
    v_max3_f32 v190, |v183|, |v184|, |v185|
    v_add_f32 v197, v197, v198
    v_max3_f32 v188, v188, |v186|, |v187|
    v_add_f32 v189, v189, v197
    v_max_f32 v188, v188, v190
    ds_write_b32 v121, v189
    v_cmp_nge_f32 vcc, s3, v188
    s_cbranch_vccnz L_unsafe_45
L_unsafe2_46:
    s_mov_b64 exec, -1
    s_waitcnt lgkmcnt(0)
    s_barrier
    s_nop 0
    ds_read_b128 v[208:211], v120 offset:0
    ds_read_b128 v[212:215], v120 offset:256
    ds_read_b128 v[216:219], v120 offset:512
    ds_read_b128 v[220:223], v120 offset:768
    ds_read_b32 v190, v122
    ds_read_b32 v191, v131 offset:4
    s_waitcnt lgkmcnt(0)
    v_cmp_ne_u32 vcc, 0, v191
    s_cbranch_vccnz L_smax_43
L_sback_44:
    v_mfma_f32_16x16x32_bf16 v[240:243], v[48:51], v[208:211], 0
    v_add_f32_dpp v190, v190, v190 row_ror:4 row_mask:0xf bank_mask:0xf
    s_nop 1
    v_mfma_f32_16x16x32_bf16 v[244:247], v[64:67], v[208:211], 0
    v_add_f32_dpp v190, v190, v190 row_ror:8 row_mask:0xf bank_mask:0xf
    v_mov_b32 v191, v190
    v_mfma_f32_16x16x32_bf16 v[240:243], v[52:55], v[212:215], v[240:243]
    s_nop 0
    v_permlane16_swap_b32 v190, v191
    v_mfma_f32_16x16x32_bf16 v[244:247], v[68:71], v[212:215], v[244:247]
    v_add_f32 v190, v190, v191
    v_mov_b32 v191, v190
    v_mfma_f32_16x16x32_bf16 v[240:243], v[56:59], v[216:219], v[240:243]
    s_nop 0
    v_permlane32_swap_b32 v190, v191
    v_mfma_f32_16x16x32_bf16 v[244:247], v[72:75], v[216:219], v[244:247]
    v_add_f32 v133, v190, v191
    v_mfma_f32_16x16x32_bf16 v[240:243], v[60:63], v[220:223], v[240:243]
    v_mfma_f32_16x16x32_bf16 v[244:247], v[76:79], v[220:223], v[244:247]
    s_nop 6
    s_nop 0
    v_bfi_b32 v240, s15, v127, v240
    v_bfi_b32 v241, s15, v127, v241
    v_bfi_b32 v242, s15, v127, v242
    v_bfi_b32 v243, s15, v127, v243
    v_bfi_b32 v244, s15, v127, v244
    v_bfi_b32 v245, s15, v127, v245
    v_bfi_b32 v246, s15, v127, v246
    v_bfi_b32 v247, s15, v127, v247
    s_mov_b64 exec, s[12:13]
    s_cmp_eq_u32 s16, 0
    s_cbranch_scc1 L_slow_47
    buffer_store_dwordx4 v[132:135], v8, s[80:83], s28 offen
    s_mov_b64 exec, s[8:9]
    buffer_store_dwordx4 v[240:243], v5, s[80:83], s27 offen
    buffer_store_dwordx4 v[244:247], v5, s[80:83], s27 offen offset:16
L_pubd_48:
    s_mov_b64 exec, -1
    s_mov_b32 s18, 60000
L_poll_rs_49:
    buffer_load_dwordx4 v[164:167], v6, s[80:83], s27 offen sc1
    buffer_load_dwordx4 v[168:171], v7, s[80:83], s28 offen sc1
    s_sub_u32 s18, s18, 1
    s_cbranch_scc1 L_bail
    s_waitcnt vmcnt(0)
    v_bitop3_b32 v220, v164, v165, v127 bitop3:0x7e
    v_bitop3_b32 v221, v166, v167, v127 bitop3:0x7e
    v_bitop3_b32 v220, v220, v221, s15 bitop3:0xa8
    v_xor_b32 v221, s14, v170
    v_bitop3_b32 v222, v171, s14, -16 bitop3:0x28
    v_or3_b32 v220, v220, v221, v222
    v_cmp_ne_u32 vcc, 0, v220
    s_cbranch_vccnz L_poll_rs_49
    v_cmp_ne_u32 vcc, 0, v168
    v_and_b32 v164, 0xfffff000, v164
    v_and_b32 v165, 0xfffff000, v165
    v_and_b32 v166, 0xfffff000, v166
    v_and_b32 v167, 0xfffff000, v167
    v_mov_b32 v175, v169
    s_cbranch_vccnz L_s3max_50
L_s3back_51:
    v_permlane16_swap_b32 v164, v166
    v_permlane16_swap_b32 v165, v167
    v_mov_b32 v173, v175
    v_add_f32 v164, v164, v166
    v_add_f32 v165, v165, v167
    v_permlane16_swap_b32 v175, v173
    v_add_f32 v175, v175, v173
    s_nop 1
    v_add_f32_dpp v175, v175, v175 row_ror:8 row_mask:0xf bank_mask:0xf
    v_add_f32_dpp v164, v164, v164 row_ror:8 row_mask:0xf bank_mask:0xf
    v_add_f32_dpp v165, v165, v165 row_ror:8 row_mask:0xf bank_mask:0xf
    v_add_f32_dpp v175, v175, v175 row_ror:4 row_mask:0xf bank_mask:0xf
    v_add_f32_dpp v164, v164, v164 row_ror:4 row_mask:0xf bank_mask:0xf
    v_add_f32_dpp v165, v165, v165 row_ror:4 row_mask:0xf bank_mask:0xf
    v_add_f32_dpp v175, v175, v175 row_ror:2 row_mask:0xf bank_mask:0xf
    v_add_f32_dpp v164, v164, v164 row_ror:2 row_mask:0xf bank_mask:0xf
    v_add_f32_dpp v165, v165, v165 row_ror:2 row_mask:0xf bank_mask:0xf
    v_add_f32_dpp v175, v175, v175 row_ror:1 row_mask:0xf bank_mask:0xf
    v_add_f32_dpp v164, v164, v164 row_ror:1 row_mask:0xf bank_mask:0xf
    v_add_f32_dpp v165, v165, v165 row_ror:1 row_mask:0xf bank_mask:0xf
    v_rcp_f32 v175, v175
    s_nop 0
    v_mul_f32 v164, v175, v164
    v_mul_f32 v165, v175, v165
    v_cvt_pk_bf16_f32 v164, v164, v165
    s_mov_b32 exec_lo, 0x00010001
    s_mov_b32 exec_hi, 0x00010001
    s_cmp_eq_u32 s16, 0
    s_cbranch_scc1 L_slow_52
    buffer_store_dword v164, v9, s[80:83], s29 offen
L_pubd_53:
    s_mov_b64 exec, -1
    s_cmp_ge_u32 s6, 2
    s_cbranch_scc1 L_w_b5_54
    s_mov_b32 s18, 60000
L_poll_o_55:
    buffer_load_dwordx4 v[96:99], v3, s[80:83], s29 offen offset:0 sc1
    buffer_load_dwordx4 v[100:103], v3, s[80:83], s29 offen offset:256 sc1
    buffer_load_dwordx4 v[104:107], v3, s[80:83], s29 offen offset:512 sc1
    buffer_load_dwordx4 v[108:111], v3, s[80:83], s29 offen offset:768 sc1
    s_sub_u32 s18, s18, 1
    s_cbranch_scc1 L_bail
    s_waitcnt vmcnt(0)
    v_max3_u32 v224, v96, v97, v98
    v_max3_u32 v225, v99, v100, v101
    v_max3_u32 v226, v102, v103, v104
    v_max3_u32 v227, v105, v106, v107
    v_max3_u32 v224, v224, v108, v109
    v_max3_u32 v225, v225, v110, v111
    v_max3_u32 v224, v224, v226, v227
    v_max_u32 v224, v224, v225
    v_cmp_eq_u32 vcc, -1, v224
    s_cbranch_vccnz L_poll_o_55
    s_nop 0
    v_mfma_f32_16x16x32_bf16 v[140:143], v[96:99], a[64:67], 0
    v_mfma_f32_16x16x32_bf16 v[144:147], v[96:99], a[68:71], 0
    v_mfma_f32_16x16x32_bf16 v[148:151], v[96:99], a[72:75], 0
    v_mfma_f32_16x16x32_bf16 v[152:155], v[96:99], a[76:79], 0
    v_mfma_f32_16x16x32_bf16 v[140:143], v[100:103], a[80:83], v[140:143]
    v_mfma_f32_16x16x32_bf16 v[144:147], v[100:103], a[84:87], v[144:147]
    v_mfma_f32_16x16x32_bf16 v[148:151], v[100:103], a[88:91], v[148:151]
    v_mfma_f32_16x16x32_bf16 v[152:155], v[100:103], a[92:95], v[152:155]
    v_mfma_f32_16x16x32_bf16 v[140:143], v[104:107], a[96:99], v[140:143]
    v_mfma_f32_16x16x32_bf16 v[144:147], v[104:107], a[100:103], v[144:147]
    v_mfma_f32_16x16x32_bf16 v[148:151], v[104:107], a[104:107], v[148:151]
    v_mfma_f32_16x16x32_bf16 v[152:155], v[104:107], a[108:111], v[152:155]
    v_mfma_f32_16x16x32_bf16 v[140:143], v[108:111], a[112:115], v[140:143]
    v_mfma_f32_16x16x32_bf16 v[144:147], v[108:111], a[116:119], v[144:147]
    v_mfma_f32_16x16x32_bf16 v[148:151], v[108:111], a[120:123], v[148:151]
    v_mfma_f32_16x16x32_bf16 v[152:155], v[108:111], a[124:127], v[152:155]
    s_nop 5
    v_add_f32 v176, v140, v145
    s_nop 0
    v_add_f32 v177, v150, v155
    v_add_f32 v176, v176, v177
    v_bfi_b32 v176, s15, v127, v176
    buffer_store_dword v176, v10, s[80:83], s30 offen sc1
    s_add_u32 s19, s30, 131072
    buffer_store_dword v176, v10, s[80:83], s19 offen sc1
    s_nop 15
    s_nop 15
    s_nop 15
    s_nop 15
    s_nop 15
    s_nop 15
    s_nop 15
    s_nop 15
    s_mov_b32 s18, 60000
L_poll_c1_56:
    buffer_load_dwordx2 v[164:165], v11, s[80:83], s30 offen sc1
    s_sub_u32 s18, s18, 1
    s_cbranch_scc1 L_bail
    s_waitcnt vmcnt(0)
    v_bitop3_b32 v168, v164, v165, v127 bitop3:0x7e
    v_and_b32 v168, s15, v168
    v_cmp_ne_u32 vcc, 0, v168
    s_cbranch_vccnz L_poll_c1_56
    v_and_b32 v164, 0xfffff000, v164
    v_and_b32 v165, 0xfffff000, v165
    v_lshlrev_b32 v167, 16, v125
    s_nop 0
    v_permlane32_swap_b32 v164, v165
    v_add_f32 v164, v164, v165
    v_mov_b32 v165, v164
    s_nop 1
    v_permlane16_swap_b32 v164, v165
    v_add_f32 v164, v164, v165
    s_nop 1
    v_add_f32_dpp v164, v164, v164 row_ror:8 row_mask:0xf bank_mask:0xf
    v_add_f32 v164, v164, v167
    v_mov_b32 v165, v164
    s_nop 1
    v_permlane32_swap_b32 v164, v165
    v_cvt_pk_bf16_f32 v164, v164, v165
    s_mov_b64 exec, 0xff
    s_cmp_eq_u32 s36, 0
    s_cbranch_scc1 L_slow_57
    buffer_store_dword v164, v13, s[80:83], s31 offen
L_pubd_58:
    s_mov_b64 exec, -1
L_w_b5_54:
    s_barrier
    s_mov_b32 s18, 60000
L_poll_gu_59:
    buffer_load_ushort v164, v15, s[80:83], s32 offen sc1
    buffer_load_ushort v165, v15, s[80:83], s32 offen offset:512 sc1
    buffer_load_ushort v126, v12, s[80:83], s31 offen sc1
    s_sub_u32 s18, s18, 1
    s_cbranch_scc1 L_bail
    s_waitcnt vmcnt(0)
    v_max3_u32 v166, v164, v165, v126
    v_cmp_eq_u32 vcc, 0xffff, v166
    s_cbranch_vccnz L_poll_gu_59
    v_lshlrev_b32 v164, 16, v164
    v_lshlrev_b32 v165, 16, v165
    v_mul_f32 v166, 0xbfb8aa3b, v164
    v_mul_f32 v164, v164, v165
    v_exp_f32 v166, v166
    s_nop 0
    v_add_f32 v166, 1.0, v166
    v_rcp_f32 v166, v166
    s_nop 0
    v_mul_f32 v164, v164, v166
    v_cvt_pk_bf16_f32 v164, v164, v164
    ds_write_b16 v123, v164
    s_waitcnt lgkmcnt(0)
    s_barrier
    s_cmp_ge_u32 s6, 2
    s_cbranch_scc1 L_W_END
    ds_read_b128 v[164:167], v124
    ds_read_b128 v[168:171], v124 offset:256
    s_waitcnt lgkmcnt(0)
    v_mfma_f32_16x16x32_bf16 v[140:143], v[164:167], a[128:131], 0
    v_mfma_f32_16x16x32_bf16 v[144:147], v[164:167], a[132:135], 0
    v_mfma_f32_16x16x32_bf16 v[148:151], v[164:167], a[136:139], 0
    v_mfma_f32_16x16x32_bf16 v[152:155], v[164:167], a[140:143], 0
    v_mfma_f32_16x16x32_bf16 v[140:143], v[168:171], a[144:147], v[140:143]
    v_mfma_f32_16x16x32_bf16 v[144:147], v[168:171], a[148:151], v[144:147]
    v_mfma_f32_16x16x32_bf16 v[148:151], v[168:171], a[152:155], v[148:151]
    s_nop 5
    v_add_f32 v176, v155, v140
    s_nop 0
    v_add_f32 v177, v145, v150
    v_add_f32 v176, v176, v177
    v_bfi_b32 v176, s15, v127, v176
    s_mov_b64 exec, 0xffff
    buffer_store_dword v176, v10, s[80:83], s33 offen sc1
    s_mov_b64 exec, -1
    s_cmp_lg_u32 s4, 0
    s_cbranch_scc1 L_W_END
    s_nop 15
    s_nop 15
    s_nop 15
    s_nop 15
    s_nop 15
    s_nop 15
    s_nop 15
    s_nop 15
    s_mov_b32 s18, 60000
L_poll_c2_60:
    buffer_load_dwordx2 v[164:165], v11, s[80:83], s33 offen sc1
    s_sub_u32 s18, s18, 1
    s_cbranch_scc1 L_bail
    s_waitcnt vmcnt(0)
    v_bitop3_b32 v168, v164, v165, v127 bitop3:0x7e
    v_and_b32 v168, s15, v168
    v_cmp_ne_u32 vcc, 0, v168
    s_cbranch_vccnz L_poll_c2_60
    v_and_b32 v164, 0xfffff000, v164
    v_and_b32 v165, 0xfffff000, v165
    v_lshlrev_b32 v167, 16, v126
    s_nop 0
    v_permlane32_swap_b32 v164, v165
    v_add_f32 v164, v164, v165
    v_mov_b32 v165, v164
    s_nop 1
    v_permlane16_swap_b32 v164, v165
    v_add_f32 v164, v164, v165
    s_nop 1
    v_add_f32_dpp v164, v164, v164 row_ror:8 row_mask:0xf bank_mask:0xf
    v_add_f32 v164, v164, v167
    v_mov_b32 v165, v164
    s_nop 1
    v_permlane32_swap_b32 v164, v165
    v_cvt_pk_bf16_f32 v164, v164, v165
    s_mov_b64 exec, 0xff
    buffer_store_dword v164, v129, s[72:75], 0 offen
    s_or_b32 s19, s7, s6
    s_cmp_lg_u32 s19, 0
    s_cbranch_scc1 L_epoch_61
    v_mov_b32 v168, s14
    v_mov_b32 v169, 77824
    s_mov_b64 exec, 1
    buffer_store_dword v168, v169, s[80:83], 0 offen
L_epoch_61:
    s_mov_b64 exec, -1
L_W_END:
    s_endpgm
L_slow_6:
    buffer_store_dword v176, v178, s[80:83], s38 offen sc1
    s_branch L_pubd_7
L_wB0_5:
    s_barrier
    s_lshl_b32 s22, s4, 23
    s_lshl_b32 s20, s6, 18
    s_add_u32 s22, s22, s20
    s_lshl_b32 s20, s5, 12
    s_add_u32 s22, s22, s20
    s_add_u32 s22, s22, 7340032
    s_add_u32 s23, s22, 131072
    s_lshl_b32 s21, s6, 13
    v_lshrrev_b32 v222, 4, v1
    v_and_b32 v224, 15, v1
    v_lshlrev_b32 v225, 8, v222
    v_xor_b32 v223, v222, v224
    v_lshl_add_u32 v228, v223, 4, v225
    v_xor_b32 v229, 64, v228
    v_xor_b32 v230, 128, v228
    v_xor_b32 v231, 192, v228
    s_add_u32 m0, s21, 32768
    s_nop 0
    buffer_load_dwordx4 v228, s[44:47], s22 offen offset:0 nt lds
    buffer_load_dwordx4 v229, s[44:47], s22 offen offset:1024 nt lds
    buffer_load_dwordx4 v230, s[44:47], s22 offen offset:2048 nt lds
    buffer_load_dwordx4 v231, s[44:47], s22 offen offset:3072 nt lds
    s_add_u32 m0, s21, 36864
    s_nop 0
    buffer_load_dwordx4 v228, s[44:47], s23 offen offset:0 nt lds
    buffer_load_dwordx4 v229, s[44:47], s23 offen offset:1024 nt lds
    buffer_load_dwordx4 v230, s[44:47], s23 offen offset:2048 nt lds
    buffer_load_dwordx4 v231, s[44:47], s23 offen offset:3072 nt lds
    s_branch L_wfq_8
L_unsafe_17:
    v_mov_b32 v190, 115792
    v_mov_b32 v191, 1
    ds_write_b32 v190, v191
    s_branch L_unsafe2_18
L_smax_15:
    v_max3_f32 v188, v180, v181, v182
    v_max3_f32 v189, v183, v184, v185
    v_max3_f32 v188, v188, v186, v187
    v_max_f32 v188, v188, v189
    v_mov_b32 v189, v188
    s_nop 1
    v_permlane16_swap_b32 v188, v189
    v_max_f32 v188, v188, v189
    v_mov_b32 v189, v188
    s_nop 1
    v_permlane32_swap_b32 v188, v189
    v_max_f32 v188, v188, v189
    s_mov_b64 exec, 15
    ds_write_b32 v117, v188
    s_mov_b64 exec, -1
    s_waitcnt lgkmcnt(0)
    s_barrier
    ds_read_b128 v[192:195], v118
    s_waitcnt lgkmcnt(0)
    v_max3_f32 v188, v192, v193, v194
    v_max_f32 v188, v188, v195
    v_mov_b32 v132, v188
    v_sub_f32 v200, v180, v188
    v_sub_f32 v201, v181, v188
    v_sub_f32 v202, v182, v188
    v_sub_f32 v203, v183, v188
    v_sub_f32 v204, v184, v188
    v_sub_f32 v205, v185, v188
    v_sub_f32 v206, v186, v188
    v_sub_f32 v207, v187, v188
    v_exp_f32 v200, v200
    v_exp_f32 v201, v201
    v_exp_f32 v202, v202
    v_exp_f32 v203, v203
    v_exp_f32 v204, v204
    v_exp_f32 v205, v205
    v_exp_f32 v206, v206
    v_exp_f32 v207, v207
    v_cvt_pk_bf16_f32 v192, v200, v201
    v_cvt_pk_bf16_f32 v193, v202, v203
    v_cvt_pk_bf16_f32 v194, v204, v205
    v_cvt_pk_bf16_f32 v195, v206, v207
    v_add_f32 v189, v200, v201
    v_add_f32 v196, v202, v203
    v_add_f32 v197, v204, v205
    v_add_f32 v198, v206, v207
    v_add_f32 v189, v189, v196
    v_add_f32 v197, v197, v198
    v_add_f32 v189, v189, v197
    s_mov_b64 exec, s[8:9]
    ds_write_b128 v119, v[192:195]
    ds_write_b32 v121, v189
    s_mov_b64 exec, -1
    s_waitcnt lgkmcnt(0)
    s_barrier
    ds_read_b128 v[208:211], v120 offset:0
    ds_read_b128 v[212:215], v120 offset:256
    ds_read_b128 v[216:219], v120 offset:512
    ds_read_b128 v[220:223], v120 offset:768
    ds_read_b32 v190, v122
    s_waitcnt lgkmcnt(0)
    s_branch L_sback_16
L_slow_19:
    buffer_store_dwordx4 v[132:135], v8, s[80:83], s28 offen sc1
    s_mov_b64 exec, s[8:9]
    buffer_store_dwordx4 v[240:243], v5, s[80:83], s27 offen sc1
    buffer_store_dwordx4 v[244:247], v5, s[80:83], s27 offen offset:16 sc1
    s_branch L_pubd_20
L_s3max_22:
    v_max_f32_dpp v172, v168, v168 row_ror:1 row_mask:0xf bank_mask:0xf
    s_nop 1
    v_max_f32_dpp v172, v172, v172 row_ror:2 row_mask:0xf bank_mask:0xf
    s_nop 1
    v_max_f32_dpp v172, v172, v172 row_ror:4 row_mask:0xf bank_mask:0xf
    s_nop 1
    v_max_f32_dpp v172, v172, v172 row_ror:8 row_mask:0xf bank_mask:0xf
    v_mov_b32 v173, v172
    s_nop 1
    v_permlane16_swap_b32 v172, v173
    v_max_f32 v172, v172, v173
    v_sub_f32 v174, v168, v172
    v_exp_f32 v174, v174
    s_nop 0
    v_mul_f32 v164, v174, v164
    v_mul_f32 v165, v174, v165
    v_mul_f32 v166, v174, v166
    v_mul_f32 v167, v174, v167
    v_mul_f32 v175, v174, v169
    s_branch L_s3back_23
L_slow_24:
    buffer_store_dword v164, v9, s[80:83], s29 offen sc1
    s_branch L_pubd_25
L_slow_30:
    buffer_store_dword v164, v13, s[80:83], s31 offen sc1
    s_branch L_pubd_31
L_slow_35:
    buffer_store_dword v164, v13, s[80:83], s34 offen sc1
    s_branch L_pubd_36
L_slow_39:
    buffer_store_dword v176, v14, s[80:83], s26 offen sc1
    s_branch L_pubd_40
L_unsafe_45:
    v_mov_b32 v190, 115796
    v_mov_b32 v191, 1
    ds_write_b32 v190, v191
    s_branch L_unsafe2_46
L_smax_43:
    v_max3_f32 v188, v180, v181, v182
    v_max3_f32 v189, v183, v184, v185
    v_max3_f32 v188, v188, v186, v187
    v_max_f32 v188, v188, v189
    v_mov_b32 v189, v188
    s_nop 1
    v_permlane16_swap_b32 v188, v189
    v_max_f32 v188, v188, v189
    v_mov_b32 v189, v188
    s_nop 1
    v_permlane32_swap_b32 v188, v189
    v_max_f32 v188, v188, v189
    s_mov_b64 exec, 15
    ds_write_b32 v117, v188
    s_mov_b64 exec, -1
    s_waitcnt lgkmcnt(0)
    s_barrier
    ds_read_b128 v[192:195], v118
    s_waitcnt lgkmcnt(0)
    v_max3_f32 v188, v192, v193, v194
    v_max_f32 v188, v188, v195
    v_mov_b32 v132, v188
    v_sub_f32 v200, v180, v188
    v_sub_f32 v201, v181, v188
    v_sub_f32 v202, v182, v188
    v_sub_f32 v203, v183, v188
    v_sub_f32 v204, v184, v188
    v_sub_f32 v205, v185, v188
    v_sub_f32 v206, v186, v188
    v_sub_f32 v207, v187, v188
    v_exp_f32 v200, v200
    v_exp_f32 v201, v201
    v_exp_f32 v202, v202
    v_exp_f32 v203, v203
    v_exp_f32 v204, v204
    v_exp_f32 v205, v205
    v_exp_f32 v206, v206
    v_exp_f32 v207, v207
    v_cvt_pk_bf16_f32 v192, v200, v201
    v_cvt_pk_bf16_f32 v193, v202, v203
    v_cvt_pk_bf16_f32 v194, v204, v205
    v_cvt_pk_bf16_f32 v195, v206, v207
    v_add_f32 v189, v200, v201
    v_add_f32 v196, v202, v203
    v_add_f32 v197, v204, v205
    v_add_f32 v198, v206, v207
    v_add_f32 v189, v189, v196
    v_add_f32 v197, v197, v198
    v_add_f32 v189, v189, v197
    s_mov_b64 exec, s[8:9]
    ds_write_b128 v119, v[192:195]
    ds_write_b32 v121, v189
    s_mov_b64 exec, -1
    s_waitcnt lgkmcnt(0)
    s_barrier
    ds_read_b128 v[208:211], v120 offset:0
    ds_read_b128 v[212:215], v120 offset:256
    ds_read_b128 v[216:219], v120 offset:512
    ds_read_b128 v[220:223], v120 offset:768
    ds_read_b32 v190, v122
    s_waitcnt lgkmcnt(0)
    s_branch L_sback_44
L_slow_47:
    buffer_store_dwordx4 v[132:135], v8, s[80:83], s28 offen sc1
    s_mov_b64 exec, s[8:9]
    buffer_store_dwordx4 v[240:243], v5, s[80:83], s27 offen sc1
    buffer_store_dwordx4 v[244:247], v5, s[80:83], s27 offen offset:16 sc1
    s_branch L_pubd_48
L_s3max_50:
    v_max_f32_dpp v172, v168, v168 row_ror:1 row_mask:0xf bank_mask:0xf
    s_nop 1
    v_max_f32_dpp v172, v172, v172 row_ror:2 row_mask:0xf bank_mask:0xf
    s_nop 1
    v_max_f32_dpp v172, v172, v172 row_ror:4 row_mask:0xf bank_mask:0xf
    s_nop 1
    v_max_f32_dpp v172, v172, v172 row_ror:8 row_mask:0xf bank_mask:0xf
    v_mov_b32 v173, v172
    s_nop 1
    v_permlane16_swap_b32 v172, v173
    v_max_f32 v172, v172, v173
    v_sub_f32 v174, v168, v172
    v_exp_f32 v174, v174
    s_nop 0
    v_mul_f32 v164, v174, v164
    v_mul_f32 v165, v174, v165
    v_mul_f32 v166, v174, v166
    v_mul_f32 v167, v174, v167
    v_mul_f32 v175, v174, v169
    s_branch L_s3back_51
L_slow_52:
    buffer_store_dword v164, v9, s[80:83], s29 offen sc1
    s_branch L_pubd_53
L_slow_57:
    buffer_store_dword v164, v13, s[80:83], s31 offen sc1
    s_branch L_pubd_58
L_F:
    s_lshl_b32 s19, s5, 17
    s_lshl_b32 s20, s6, 15
    s_add_u32 s19, s19, s20
    s_lshl_b32 s20, s4, 10
    s_add_u32 s19, s19, s20
    s_mov_b32 m0, 114688
    s_nop 0
    buffer_load_dwordx4 v2, s[52:55], s19 offen  lds
    s_add_u32 s19, s19, 8192
    buffer_load_dwordx4 v2, s[52:55], s19 offen  lds
    s_add_u32 s19, s19, 8192
    buffer_load_dwordx4 v2, s[52:55], s19 offen  lds
    s_add_u32 s19, s19, 8192
    buffer_load_dwordx4 v2, s[52:55], s19 offen  lds
    s_cmp_lg_u32 s6, 3
    s_cbranch_scc1 L_noxt_62
    s_waitcnt lgkmcnt(0)
    s_add_u32 s19, s14, 0x1011
    s_and_b32 s19, s19, 0xfffffff0
    s_or_b32 s19, s19, s39
    s_lshl_b32 s20, s4, 7
    s_lshl_b32 s21, s5, 2
    s_add_u32 s20, s20, s21
    s_add_u32 s20, s20, 73728
    v_mov_b32 v237, s19
    v_mov_b32 v238, 0
    s_mov_b64 exec, 1
    buffer_store_dword v237, v238, s[80:83], s20 offen sc1
    s_mov_b64 exec, -1
L_noxt_62:
    s_cmp_lg_u32 s6, 2
    s_cbranch_scc1 L_nopf_63
    s_getpc_b64 s[10:11]
L_pc_64:
    s_sub_u32 s10, s10, L_pc_64-L_F
    s_subb_u32 s11, s11, 0
    v_lshlrev_b32 v238, 6, v1
    v_min_u32 v239, L_bail-L_F-4, v238
    global_load_dword v255, v239, s[10:11]
    v_add_u32 v238, 4096, v238
    v_min_u32 v239, L_bail-L_F-4, v238
    global_load_dword v255, v239, s[10:11]
L_nopf_63:
    s_waitcnt vmcnt(0)
    s_lshl_b32 s22, s4, 23
    s_lshl_b32 s20, s6, 18
    s_add_u32 s22, s22, s20
    s_lshl_b32 s20, s5, 12
    s_add_u32 s22, s22, s20
    s_add_u32 s22, s22, 7340032
    s_add_u32 s23, s22, 131072
    s_lshl_b32 s21, s6, 13
    v_lshrrev_b32 v222, 4, v1
    v_and_b32 v224, 15, v1
    v_lshlrev_b32 v223, 1, v222
    v_lshlrev_b32 v225, 8, v222
    v_xor_b32 v223, v223, v224
    v_lshl_add_u32 v226, v223, 4, v225
    v_xor_b32 v227, 128, v226
    s_add_u32 m0, s21, 0
    s_nop 0
    buffer_load_dwordx4 v226, s[48:51], s22 offen offset:0 nt lds
    buffer_load_dwordx4 v227, s[48:51], s22 offen offset:1024 nt lds
    buffer_load_dwordx4 v226, s[48:51], s22 offen offset:2048 nt lds
    buffer_load_dwordx4 v227, s[48:51], s22 offen offset:3072 nt lds
    s_add_u32 m0, s21, 4096
    s_nop 0
    buffer_load_dwordx4 v226, s[48:51], s23 offen offset:0 nt lds
    buffer_load_dwordx4 v227, s[48:51], s23 offen offset:1024 nt lds
    buffer_load_dwordx4 v226, s[48:51], s23 offen offset:2048 nt lds
    buffer_load_dwordx4 v227, s[48:51], s23 offen offset:3072 nt lds
    v_lshrrev_b32 v222, 4, v1
    v_and_b32 v224, 15, v1
    v_lshlrev_b32 v225, 8, v222
    v_xor_b32 v223, v222, v224
    v_lshl_add_u32 v228, v223, 4, v225
    v_xor_b32 v229, 64, v228
    v_xor_b32 v230, 128, v228
    v_xor_b32 v231, 192, v228
    s_add_u32 m0, s21, 32768
    s_nop 0
    buffer_load_dwordx4 v228, s[44:47], s22 offen offset:0 nt lds
    buffer_load_dwordx4 v229, s[44:47], s22 offen offset:1024 nt lds
    buffer_load_dwordx4 v230, s[44:47], s22 offen offset:2048 nt lds
    buffer_load_dwordx4 v231, s[44:47], s22 offen offset:3072 nt lds
    s_add_u32 m0, s21, 36864
    s_nop 0
    buffer_load_dwordx4 v228, s[44:47], s23 offen offset:0 nt lds
    buffer_load_dwordx4 v229, s[44:47], s23 offen offset:1024 nt lds
    buffer_load_dwordx4 v230, s[44:47], s23 offen offset:2048 nt lds
    buffer_load_dwordx4 v231, s[44:47], s23 offen offset:3072 nt lds
    s_lshl_b32 s19, s7, 2
    s_add_u32 s19, s19, s6
    s_lshl_b32 s20, s19, 10
    s_lshl_b32 s21, s4, 16
    s_add_u32 s20, s20, s21
    s_add_u32 s20, s20, 131072
    s_mov_b32 m0, 114688
    s_nop 0
    buffer_load_dwordx4 v2, s[80:83], s20 offen lds
    s_lshr_b32 s21, s19, 1
    s_lshl_b32 s21, s21, 14
    s_and_b32 s22, s19, 1
    s_lshl_b32 s22, s22, 10
    s_add_u32 s21, s21, s22
    s_lshl_b32 s22, s4, 11
    s_add_u32 s21, s21, s22
    s_add_u32 s21, s21, 81920
    s_cmp_lt_u32 s19, 4
    s_cselect_b32 s21, s21, 0x10000000
    s_and_b32 s22, s19, 1
    s_lshl_b32 s22, s22, 10
    s_lshl_b32 s23, s4, 11
    s_add_u32 s22, s22, s23
    s_add_u32 s22, s22, 114688
    s_lshr_b32 s23, s19, 1
    s_cmp_eq_u32 s23, 2
    s_cselect_b32 s21, s22, s21
    buffer_load_dwordx4 v2, s[80:83], s21 offen lds
    s_add_u32 s20, s20, 524288
    buffer_load_dwordx4 v2, s[80:83], s20 offen lds
    v_and_b32 v222, 15, v1
    v_lshrrev_b32 v223, 4, v1
    v_lshlrev_b32 v224, 4, v223
    v_and_b32 v225, 3, v222
    v_lshlrev_b32 v226, 4, v225
    v_lshl_add_u32 v3, v223, 6, v226
    v_add_u32 v130, 117632, v2
    s_lshl_b32 s19, s6, 12
    s_lshl_b32 s20, s5, 5
    s_add_u32 s19, s19, s20
    v_lshlrev_b32 v226, 14, v222
    v_lshl_add_u32 v226, v223, 10, v226
    v_add_u32 v5, s19, v226
    s_lshl_b32 s20, s5, 4
    v_lshlrev_b32 v226, 9, v225
    v_add_u32 v8, s20, v226
    s_lshl_b32 s19, s6, 2
    s_add_u32 s19, s19, 115712
    v_lshlrev_b32 v226, 4, v225
    v_add_u32 v117, s19, v226
    v_add_u32 v118, 115712, v226
    v_lshlrev_b32 v227, 6, v225
    v_add_u32 v226, v227, v224
    v_add_u32 v120, 115840, v226
    s_lshl_b32 s19, s6, 8
    v_add_u32 v119, s19, v120
    s_lshl_b32 s19, s6, 4
    s_add_u32 s20, s19, 116864
    v_lshl_add_u32 v228, v223, 2, v227
    v_add_u32 v121, s20, v228
    v_and_b32 v228, 60, v1
    v_add_u32 v228, v228, v227
    v_add_u32 v122, 116864, v228
    s_mov_b32 s8, 0x000f000f
    s_mov_b32 s9, 0x000f000f
    s_mov_b32 s24, 0x0fff0fff
    s_mov_b32 s25, 0x0fff0fff
    s_mov_b32 s35, 0x3e0293ee
    s_mov_b32 s3, 0x42200000
    s_cmp_eq_u32 s6, 3
    s_cselect_b32 s12, 15, 0
    s_mov_b32 s13, 0
    v_mov_b32 v131, 115792
    v_mov_b32 v226, 0
    v_mov_b32 v227, 0
    ds_write_b64 v131, v[226:227]
    s_lshl_b32 s19, s4, 10
    s_add_u32 s26, s19, 8192
    s_add_u32 s29, s19, 16384
    s_add_u32 s31, s19, 32768
    s_add_u32 s32, s19, 49152
    s_add_u32 s34, s19, 65536
    s_lshl_b32 s19, s4, 11
    s_add_u32 s28, s19, 81920
    s_add_u32 s38, s19, 114688
    s_lshl_b32 s19, s4, 16
    s_add_u32 s27, s19, 131072
    s_mov_b32 s30, 1179648
    s_mov_b32 s33, 1703936
    s_mov_b32 s58, 4194304
    s_mov_b32 s59, 0x20000
    s_mov_b32 s62, 1835008
    s_mov_b32 s63, 0x20000
    s_mov_b32 s66, 1835008
    s_mov_b32 s67, 0x20000
    s_mov_b32 s70, 1835008
    s_mov_b32 s71, 0x20000
    s_mov_b32 s74, 1024
    s_mov_b32 s75, 0x20000
    s_mov_b32 s15, 0xfff
    s_waitcnt lgkmcnt(0)
    s_add_u32 s14, s14, 0x1011
    s_and_b32 s19, s14, 0xfff
    v_mov_b32 v127, s19
    s_and_b32 s37, s14, 0xfff0
    s_or_b32 s37, s37, s39
    s_and_b32 s19, s14, 0xfffffff0
    s_or_b32 s19, s19, s39
    v_mov_b32 v134, s14
    v_mov_b32 v135, s19
    s_nop 0
    s_mov_b32 exec_lo, 0xf000f000
    s_mov_b32 exec_hi, 0xf000f000
    v_mov_b32 v80, 0x3f803f80
    v_mov_b32 v81, 0x3f803f80
    v_mov_b32 v82, 0x3f803f80
    v_mov_b32 v83, 0x3f803f80
    v_mov_b32 v84, 0x3f803f80
    v_mov_b32 v85, 0x3f803f80
    v_mov_b32 v86, 0x3f803f80
    v_mov_b32 v87, 0x3f803f80
    v_mov_b32 v88, 0x3f803f80
    v_mov_b32 v89, 0x3f803f80
    v_mov_b32 v90, 0x3f803f80
    v_mov_b32 v91, 0x3f803f80
    v_mov_b32 v92, 0x3f803f80
    v_mov_b32 v93, 0x3f803f80
    v_mov_b32 v94, 0x3f803f80
    v_mov_b32 v95, 0x3f803f80
    s_mov_b64 exec, -1
    v_and_b32 v222, 15, v1
    v_lshlrev_b32 v224, 1, v222
    s_and_b32 s19, s7, 1
    s_lshl_b32 s19, s19, 9
    s_lshr_b32 s20, s7, 1
    s_lshl_b32 s20, s20, 6
    s_add_u32 s19, s19, s20
    s_and_b32 s20, s6, 1
    s_lshl_b32 s20, s20, 5
    s_add_u32 s19, s19, s20
    v_add_u32 v14, s19, v224
    v_lshlrev_b32 v238, 5, v1
    s_waitcnt vmcnt(11)
    s_barrier
    s_cmp_lg_u32 s6, 0
    s_cbranch_scc1 L_fq_n0_66
    buffer_load_dwordx4 v[224:227], v238, s[80:83], s38 offen sc1
    buffer_load_dwordx4 v[228:231], v238, s[80:83], s38 offen offset:16 sc1
L_fq_n0_66:
    v_lshrrev_b32 v222, 4, v1
    v_bfe_u32 v223, v1, 2, 2
    v_lshl_add_u32 v222, v222, 2, v223
    v_and_b32 v223, 7, v222
    s_lshl_b32 s19, s6, 1
    v_xor_b32 v223, s19, v223
    v_lshlrev_b32 v223, 5, v223
    v_lshl_add_u32 v222, v222, 8, v223
    v_and_b32 v223, 3, v1
    v_lshl_add_u32 v222, v223, 3, v222
    v_xor_b32 v223, 32, v222
    ds_read_b64_tr_b16 v[48:49], v222 offset:0
    ds_read_b64_tr_b16 v[50:51], v222 offset:4096
    ds_read_b64_tr_b16 v[52:53], v222 offset:8192
    ds_read_b64_tr_b16 v[54:55], v222 offset:12288
    ds_read_b64_tr_b16 v[56:57], v222 offset:16384
    ds_read_b64_tr_b16 v[58:59], v222 offset:20480
    ds_read_b64_tr_b16 v[60:61], v222 offset:24576
    ds_read_b64_tr_b16 v[62:63], v222 offset:28672
    ds_read_b64_tr_b16 v[64:65], v223 offset:0
    ds_read_b64_tr_b16 v[66:67], v223 offset:4096
    ds_read_b64_tr_b16 v[68:69], v223 offset:8192
    ds_read_b64_tr_b16 v[70:71], v223 offset:12288
    ds_read_b64_tr_b16 v[72:73], v223 offset:16384
    ds_read_b64_tr_b16 v[74:75], v223 offset:20480
    ds_read_b64_tr_b16 v[76:77], v223 offset:24576
    ds_read_b64_tr_b16 v[78:79], v223 offset:28672
    s_cmp_lg_u32 s6, 0
    s_cbranch_scc1 L_fq_k_67
    s_waitcnt vmcnt(5)
    s_branch L_fq_k2_68
L_fq_k_67:
    s_waitcnt vmcnt(3)
L_fq_k2_68:
    s_cmp_lg_u32 s6, 0
    s_cbranch_scc1 L_fq_b1_65
    s_mov_b32 s18, 60000
    v_mov_b32 v221, s37
L_q0_69:
    s_waitcnt vmcnt(0)
    v_bitop3_b32 v216, v224, v225, v221 bitop3:0x7e
    v_bitop3_b32 v217, v226, v227, v221 bitop3:0x7e
    v_bitop3_b32 v218, v228, v229, v221 bitop3:0x7e
    v_bitop3_b32 v219, v230, v231, v221 bitop3:0x7e
    v_or3_b32 v216, v216, v217, v218
    v_or_b32 v216, v216, v219
    v_and_b32 v217, 0xfff0, v216
    v_cmp_ne_u32 vcc, 0, v217
    s_cbranch_vccz L_q0ok_70
    s_sleep 2
    buffer_load_dwordx4 v[224:227], v238, s[80:83], s38 offen sc1
    buffer_load_dwordx4 v[228:231], v238, s[80:83], s38 offen offset:16 sc1
    s_sub_u32 s18, s18, 1
    s_cbranch_scc1 L_bail
    s_branch L_q0_69
L_q0ok_70:
    v_and_b32 v217, 15, v216
    v_cmp_ne_u32 vcc, 0, v217
    s_mov_b32 s19, 0x07060302
    v_perm_b32 v136, v225, v224, s19
    v_perm_b32 v137, v227, v226, s19
    v_perm_b32 v138, v229, v228, s19
    v_perm_b32 v139, v231, v230, s19
    s_cmp_eq_u64 vcc, 0
    s_cselect_b32 s20, 1, 0
    ds_write_b128 v130, v[136:139]
    v_mov_b32 v216, s20
    v_mov_b32 v217, 115776
    ds_write_b32 v217, v216
L_fq_b1_65:
    v_and_b32 v232, 15, v1
    v_lshrrev_b32 v233, 4, v1
    v_xor_b32 v233, v233, v232
    v_lshlrev_b32 v233, 4, v233
    v_lshl_add_u32 v232, v232, 8, v233
    s_lshl_b32 s19, s6, 13
    v_add_u32 v232, s19, v232
    v_xor_b32 v233, 64, v232
    v_xor_b32 v234, 128, v232
    v_xor_b32 v235, 192, v232
    ds_read_b128 v[16:19], v232 offset:32768
    ds_read_b128 v[20:23], v233 offset:32768
    ds_read_b128 v[24:27], v234 offset:32768
    ds_read_b128 v[28:31], v235 offset:32768
    ds_read_b128 v[32:35], v232 offset:36864
    ds_read_b128 v[36:39], v233 offset:36864
    ds_read_b128 v[40:43], v234 offset:36864
    ds_read_b128 v[44:47], v235 offset:36864
    s_waitcnt lgkmcnt(0)
    s_barrier
    v_mov_b32 v217, 115776
    ds_read_b128 v[136:139], v130
    ds_read_b32 v216, v217
    s_waitcnt lgkmcnt(0)
    v_readfirstlane_b32 s16, v216
    s_add_u32 s20, s4, 1
    s_lshl_b32 s20, s20, 19
    s_mov_b32 s84, s56
    s_mov_b32 s85, s57
    s_mov_b32 s86, s20
    s_mov_b32 s87, 0x20000
    s_lshl_b32 s20, s7, 2
    s_add_u32 s20, s20, s6
    s_mul_i32 s20, s20, 10240
    s_lshl_b32 s19, s4, 19
    s_add_u32 s19, s19, s20
    s_mov_b32 m0, 114688
    s_nop 0
    buffer_load_dwordx4 v2, s[84:87], s19 offen lds
    s_add_u32 s19, s19, 1024
    buffer_load_dwordx4 v2, s[84:87], s19 offen lds
    s_add_u32 s19, s19, 1024
    buffer_load_dwordx4 v2, s[84:87], s19 offen lds
    s_add_u32 s19, s19, 1024
    buffer_load_dwordx4 v2, s[84:87], s19 offen lds
    s_add_u32 s19, s19, 1024
    buffer_load_dwordx4 v2, s[84:87], s19 offen lds
    s_add_u32 s19, s19, 1024
    buffer_load_dwordx4 v2, s[84:87], s19 offen lds
    s_add_u32 s19, s19, 1024
    buffer_load_dwordx4 v2, s[84:87], s19 offen lds
    s_add_u32 s19, s19, 1024
    buffer_load_dwordx4 v2, s[84:87], s19 offen lds
    s_add_u32 s19, s19, 1024
    buffer_load_dwordx4 v2, s[84:87], s19 offen lds
    s_add_u32 s19, s19, 1024
    buffer_load_dwordx4 v2, s[84:87], s19 offen lds
    v_mfma_f32_16x16x32_bf16 v[180:183], v[16:19], v[136:139], 0
    v_mov_b32_dpp v140, v136 row_ror:12 row_mask:0xf bank_mask:0xf
    v_mov_b32_dpp v141, v137 row_ror:12 row_mask:0xf bank_mask:0xf
    v_mov_b32_dpp v142, v138 row_ror:12 row_mask:0xf bank_mask:0xf
    v_mov_b32_dpp v143, v139 row_ror:12 row_mask:0xf bank_mask:0xf
    v_mfma_f32_16x16x32_bf16 v[184:187], v[32:35], v[136:139], 0
    s_nop 0
    s_nop 0
    v_mfma_f32_16x16x32_bf16 v[180:183], v[20:23], v[140:143], v[180:183]
    v_mov_b32_dpp v144, v136 row_ror:8 row_mask:0xf bank_mask:0xf
    v_mov_b32_dpp v145, v137 row_ror:8 row_mask:0xf bank_mask:0xf
    v_mov_b32_dpp v146, v138 row_ror:8 row_mask:0xf bank_mask:0xf
    v_mov_b32_dpp v147, v139 row_ror:8 row_mask:0xf bank_mask:0xf
    v_mfma_f32_16x16x32_bf16 v[184:187], v[36:39], v[140:143], v[184:187]
    s_nop 0
    s_nop 0
    v_mfma_f32_16x16x32_bf16 v[180:183], v[24:27], v[144:147], v[180:183]
    v_mov_b32_dpp v148, v136 row_ror:4 row_mask:0xf bank_mask:0xf
    v_mov_b32_dpp v149, v137 row_ror:4 row_mask:0xf bank_mask:0xf
    v_mov_b32_dpp v150, v138 row_ror:4 row_mask:0xf bank_mask:0xf
    v_mov_b32_dpp v151, v139 row_ror:4 row_mask:0xf bank_mask:0xf
    v_mfma_f32_16x16x32_bf16 v[184:187], v[40:43], v[144:147], v[184:187]
    s_nop 0
    v_mfma_f32_16x16x32_bf16 v[180:183], v[28:31], v[148:151], v[180:183]
    v_mfma_f32_16x16x32_bf16 v[184:187], v[44:47], v[148:151], v[184:187]
    v_mov_b32 v132, 0
    s_mov_b64 exec, s[8:9]
    s_nop 4
    v_mul_f32 v180, s35, v180
    v_mul_f32 v181, s35, v181
    v_mul_f32 v182, s35, v182
    v_mul_f32 v183, s35, v183
    v_mul_f32 v184, s35, v184
    v_mul_f32 v185, s35, v185
    v_mul_f32 v186, s35, v186
    v_mul_f32 v187, s35, v187
    v_exp_f32 v200, v180
    v_exp_f32 v201, v181
    v_exp_f32 v202, v182
    v_exp_f32 v203, v183
    v_exp_f32 v204, v184
    v_exp_f32 v205, v185
    v_exp_f32 v206, v186
    v_exp_f32 v207, v187
    v_cvt_pk_bf16_f32 v192, v200, v201
    v_cvt_pk_bf16_f32 v193, v202, v203
    v_cvt_pk_bf16_f32 v194, v204, v205
    v_cvt_pk_bf16_f32 v195, v206, v207
    ds_write_b128 v119, v[192:195]
    v_add_f32 v189, v200, v201
    v_add_f32 v196, v202, v203
    v_add_f32 v197, v204, v205
    v_add_f32 v198, v206, v207
    v_max3_f32 v188, |v180|, |v181|, |v182|
    v_add_f32 v189, v189, v196
    v_max3_f32 v190, |v183|, |v184|, |v185|
    v_add_f32 v197, v197, v198
    v_max3_f32 v188, v188, |v186|, |v187|
    v_add_f32 v189, v189, v197
    v_max_f32 v188, v188, v190
    ds_write_b32 v121, v189
    v_cmp_nge_f32 vcc, s3, v188
    s_cbranch_vccnz L_unsafe_73
L_unsafe2_74:
    s_mov_b64 exec, -1
    s_waitcnt lgkmcnt(0)
    s_barrier
    s_nop 0
    ds_read_b128 v[208:211], v120 offset:0
    ds_read_b128 v[212:215], v120 offset:256
    ds_read_b128 v[216:219], v120 offset:512
    ds_read_b128 v[220:223], v120 offset:768
    ds_read_b32 v190, v122
    ds_read_b32 v191, v131 offset:0
    s_waitcnt lgkmcnt(0)
    v_cmp_ne_u32 vcc, 0, v191
    s_cbranch_vccnz L_smax_71
L_sback_72:
    v_mfma_f32_16x16x32_bf16 v[240:243], v[48:51], v[208:211], 0
    v_add_f32_dpp v190, v190, v190 row_ror:4 row_mask:0xf bank_mask:0xf
    s_nop 1
    v_mfma_f32_16x16x32_bf16 v[244:247], v[64:67], v[208:211], 0
    v_add_f32_dpp v190, v190, v190 row_ror:8 row_mask:0xf bank_mask:0xf
    v_mov_b32 v191, v190
    v_mfma_f32_16x16x32_bf16 v[240:243], v[52:55], v[212:215], v[240:243]
    s_nop 0
    v_permlane16_swap_b32 v190, v191
    v_mfma_f32_16x16x32_bf16 v[244:247], v[68:71], v[212:215], v[244:247]
    v_add_f32 v190, v190, v191
    v_mov_b32 v191, v190
    v_mfma_f32_16x16x32_bf16 v[240:243], v[56:59], v[216:219], v[240:243]
    s_nop 0
    v_permlane32_swap_b32 v190, v191
    v_mfma_f32_16x16x32_bf16 v[244:247], v[72:75], v[216:219], v[244:247]
    v_add_f32 v133, v190, v191
    v_mfma_f32_16x16x32_bf16 v[240:243], v[60:63], v[220:223], v[240:243]
    v_mfma_f32_16x16x32_bf16 v[244:247], v[76:79], v[220:223], v[244:247]
    s_nop 6
    s_nop 0
    v_bfi_b32 v240, s15, v127, v240
    v_bfi_b32 v241, s15, v127, v241
    v_bfi_b32 v242, s15, v127, v242
    v_bfi_b32 v243, s15, v127, v243
    v_bfi_b32 v244, s15, v127, v244
    v_bfi_b32 v245, s15, v127, v245
    v_bfi_b32 v246, s15, v127, v246
    v_bfi_b32 v247, s15, v127, v247
    s_mov_b64 exec, s[12:13]
    s_cmp_eq_u32 s16, 0
    s_cbranch_scc1 L_slow_75
    buffer_store_dwordx4 v[132:135], v8, s[80:83], s28 offen
    s_mov_b64 exec, s[8:9]
    buffer_store_dwordx4 v[240:243], v5, s[80:83], s27 offen
    buffer_store_dwordx4 v[244:247], v5, s[80:83], s27 offen offset:16
L_pubd_76:
    s_mov_b64 exec, -1
    s_lshl_b32 s19, s7, 2
    s_add_u32 s19, s19, s6
    s_lshl_b32 s20, s19, 13
    s_lshl_b32 s21, s4, 10
    s_add_u32 s20, s20, s21
    s_cmp_lt_u32 s19, 9
    s_cselect_b32 s20, s20, 0x10000000
    s_mov_b32 m0, 114688
    s_nop 0
    buffer_load_dwordx4 v2, s[80:83], s20 offen lds
    s_lshr_b32 s20, s19, 5
    s_lshl_b32 s20, s20, 18
    s_and_b32 s21, s19, 31
    s_lshl_b32 s21, s21, 10
    s_add_u32 s20, s20, s21
    s_lshl_b32 s22, s4, 15
    s_add_u32 s20, s20, s22
    s_add_u32 s21, s20, 1179648
    buffer_load_dwordx4 v2, s[80:83], s21 offen lds
    s_add_u32 s21, s20, 1703936
    s_cmp_lt_u32 s19, 32
    s_cselect_b32 s23, 1, 0
    s_cmp_eq_u32 s4, 0
    s_cselect_b32 s23, 1, s23
    s_cmp_eq_u32 s23, 1
    s_cselect_b32 s21, s21, 0x10000000
    buffer_load_dwordx4 v2, s[80:83], s21 offen lds
    s_add_u32 s27, s27, 524288
    s_add_u32 s28, s28, 16384
    s_cmp_ge_u32 s7, 14
    s_cbranch_scc1 L_spare_77
    s_and_b32 s19, s7, 1
    s_cmp_eq_u32 s19, 0
    s_cselect_b32 s84, s60, s64
    s_cselect_b32 s85, s61, s65
    s_mov_b32 s86, 1835008
    s_mov_b32 s87, 0x20000
    v_lshrrev_b32 v222, 5, v1
    v_and_b32 v223, 3, v1
    v_lshlrev_b32 v222, 1, v222
    v_xor_b32 v222, v222, v223
    v_lshrrev_b32 v223, 2, v1
    v_mul_u32_u24 v223, 3584, v223
    v_lshl_add_u32 v235, v222, 4, v223
    s_mul_i32 s19, s6, 458752
    s_mul_i32 s20, s4, 448
    s_add_u32 s19, s19, s20
    s_lshr_b32 s20, s7, 1
    s_lshl_b32 s20, s20, 6
    s_add_u32 s19, s19, s20
    s_lshl_b32 s20, s6, 13
    s_add_u32 s20, s20, 65536
    s_mov_b32 m0, s20
    s_nop 0
    buffer_load_dwordx4 v235, s[84:87], s19 offen offset:0 nt lds
    s_add_u32 s19, s19, 56320
    buffer_load_dwordx4 v235, s[84:87], s19 offen offset:1024 nt lds
    s_add_u32 s19, s19, 56320
    buffer_load_dwordx4 v235, s[84:87], s19 offen offset:2048 nt lds
    s_add_u32 s19, s19, 56320
    buffer_load_dwordx4 v235, s[84:87], s19 offen offset:3072 nt lds
    s_add_u32 s19, s19, 60416
    s_add_u32 m0, m0, 4096
    s_nop 0
    s_nop 0
    buffer_load_dwordx4 v235, s[84:87], s19 offen offset:0 nt lds
    s_add_u32 s19, s19, 56320
    buffer_load_dwordx4 v235, s[84:87], s19 offen offset:1024 nt lds
    s_add_u32 s19, s19, 56320
    buffer_load_dwordx4 v235, s[84:87], s19 offen offset:2048 nt lds
    s_add_u32 s19, s19, 56320
    buffer_load_dwordx4 v235, s[84:87], s19 offen offset:3072 nt lds
    s_waitcnt vmcnt(0)
    s_barrier
    s_cmp_ge_u32 s6, 2
    s_cbranch_scc1 L_F_P1
    v_lshrrev_b32 v222, 4, v1
    v_lshlrev_b32 v223, 9, v222
    v_xor_b32 v222, s6, v222
    v_and_b32 v222, 1, v222
    v_lshl_add_u32 v223, v222, 5, v223
    v_and_b32 v222, 12, v1
    v_lshl_add_u32 v223, v222, 4, v223
    v_and_b32 v222, 3, v1
    v_lshl_add_u32 v223, v222, 3, v223
    v_add_u32 v224, 65536, v223
    ds_read_b64_tr_b16 a[0:1], v224 offset:0
    ds_read_b64_tr_b16 a[2:3], v224 offset:256
    ds_read_b64_tr_b16 a[4:5], v224 offset:2048
    ds_read_b64_tr_b16 a[6:7], v224 offset:2304
    ds_read_b64_tr_b16 a[8:9], v224 offset:4096
    ds_read_b64_tr_b16 a[10:11], v224 offset:4352
    ds_read_b64_tr_b16 a[12:13], v224 offset:6144
    ds_read_b64_tr_b16 a[14:15], v224 offset:6400
    ds_read_b64_tr_b16 a[16:17], v224 offset:8192
    ds_read_b64_tr_b16 a[18:19], v224 offset:8448
    ds_read_b64_tr_b16 a[20:21], v224 offset:10240
    ds_read_b64_tr_b16 a[22:23], v224 offset:10496
    ds_read_b64_tr_b16 a[24:25], v224 offset:12288
    ds_read_b64_tr_b16 a[26:27], v224 offset:12544
    ds_read_b64_tr_b16 a[28:29], v224 offset:14336
    ds_read_b64_tr_b16 a[30:31], v224 offset:14592
    ds_read_b64_tr_b16 a[32:33], v224 offset:16384
    ds_read_b64_tr_b16 a[34:35], v224 offset:16640
    ds_read_b64_tr_b16 a[36:37], v224 offset:18432
    ds_read_b64_tr_b16 a[38:39], v224 offset:18688
    ds_read_b64_tr_b16 a[40:41], v224 offset:20480
    ds_read_b64_tr_b16 a[42:43], v224 offset:20736
    ds_read_b64_tr_b16 a[44:45], v224 offset:22528
    ds_read_b64_tr_b16 a[46:47], v224 offset:22784
    ds_read_b64_tr_b16 a[48:49], v224 offset:24576
    ds_read_b64_tr_b16 a[50:51], v224 offset:24832
    ds_read_b64_tr_b16 a[52:53], v224 offset:26624
    ds_read_b64_tr_b16 a[54:55], v224 offset:26880
    ds_read_b64_tr_b16 a[56:57], v224 offset:28672
    ds_read_b64_tr_b16 a[58:59], v224 offset:28928
    ds_read_b64_tr_b16 a[60:61], v224 offset:30720
    ds_read_b64_tr_b16 a[62:63], v224 offset:30976
    s_waitcnt lgkmcnt(0)
    s_mov_b32 s18, 60000
L_poll_x1_78:
    buffer_load_dwordx4 v[112:115], v2, s[80:83], s31 offen sc1
    s_mov_b64 exec, s[24:25]
    buffer_load_dwordx4 v[80:83], v3, s[80:83], s31 offen offset:0 sc1
    buffer_load_dwordx4 v[84:87], v3, s[80:83], s31 offen offset:256 sc1
    buffer_load_dwordx4 v[88:91], v3, s[80:83], s31 offen offset:512 sc1
    buffer_load_dwordx4 v[92:95], v3, s[80:83], s31 offen offset:768 sc1
    s_mov_b64 exec, -1
    s_sub_u32 s18, s18, 1
    s_cbranch_scc1 L_bail
    s_waitcnt vmcnt(0)
    v_max3_u32 v220, v112, v113, v114
    v_max_u32 v220, v220, v115
    v_cmp_eq_u32 vcc, -1, v220
    s_cbranch_vccnz L_poll_x1_78
    s_nop 0
    v_mov_b32 v175, 0x3f803f80
    v_mfma_f32_16x16x32_bf16 v[140:143], v[80:83], a[0:3], 0
    v_dot2_f32_bf16 v172, v112, v175, 0
    v_dot2_f32_bf16 v173, v112, v112, 0
    v_mfma_f32_16x16x32_bf16 v[144:147], v[80:83], a[4:7], 0
    v_dot2_f32_bf16 v172, v113, v175, v172
    v_dot2_f32_bf16 v173, v113, v113, v173
    v_mfma_f32_16x16x32_bf16 v[148:151], v[80:83], a[8:11], 0
    v_dot2_f32_bf16 v172, v114, v175, v172
    v_dot2_f32_bf16 v173, v114, v114, v173
    v_mfma_f32_16x16x32_bf16 v[152:155], v[80:83], a[12:15], 0
    v_dot2_f32_bf16 v172, v115, v175, v172
    v_dot2_f32_bf16 v173, v115, v115, v173
    v_mfma_f32_16x16x32_bf16 v[140:143], v[84:87], a[16:19], v[140:143]
    s_nop 1
    v_permlane32_swap_b32 v172, v173
    v_mfma_f32_16x16x32_bf16 v[144:147], v[84:87], a[20:23], v[144:147]
    v_add_f32 v172, v172, v173
    v_mov_b32 v174, v172
    v_mfma_f32_16x16x32_bf16 v[148:151], v[84:87], a[24:27], v[148:151]
    s_nop 0
    v_permlane16_swap_b32 v172, v174
    v_mfma_f32_16x16x32_bf16 v[152:155], v[84:87], a[28:31], v[152:155]
    v_add_f32 v172, v172, v174
    s_nop 0
    v_mfma_f32_16x16x32_bf16 v[140:143], v[88:91], a[32:35], v[140:143]
    v_add_f32_dpp v172, v172, v172 row_ror:8 row_mask:0xf bank_mask:0xf
    s_nop 0
    v_mfma_f32_16x16x32_bf16 v[144:147], v[88:91], a[36:39], v[144:147]
    v_add_f32_dpp v172, v172, v172 row_ror:4 row_mask:0xf bank_mask:0xf
    s_nop 0
    v_mfma_f32_16x16x32_bf16 v[148:151], v[88:91], a[40:43], v[148:151]
    v_add_f32_dpp v172, v172, v172 row_ror:2 row_mask:0xf bank_mask:0xf
    s_nop 0
    v_mfma_f32_16x16x32_bf16 v[152:155], v[88:91], a[44:47], v[152:155]
    v_add_f32_dpp v172, v172, v172 row_ror:1 row_mask:0xf bank_mask:0xf
    v_mov_b32 v173, v172
    v_mfma_f32_16x16x32_bf16 v[140:143], v[92:95], a[48:51], v[140:143]
    s_nop 0
    v_permlane32_swap_b32 v172, v173
    v_mfma_f32_16x16x32_bf16 v[144:147], v[92:95], a[52:55], v[144:147]
    v_mul_f32 v172, 0x3b000000, v172
    v_mul_f32 v173, 0x3b000000, v173
    v_mfma_f32_16x16x32_bf16 v[148:151], v[92:95], a[56:59], v[148:151]
    v_fma_f32 v173, -v172, v172, v173
    v_max_f32 v173, 0, v173
    v_mfma_f32_16x16x32_bf16 v[152:155], v[92:95], a[60:63], v[152:155]
    v_add_f32 v173, 0x3727c5ac, v173
    v_rsq_f32 v173, v173
    v_add_f32 v176, v140, v145
    s_nop 4
    v_add_f32 v177, v150, v155
    v_add_f32 v176, v176, v177
    v_mov_b32 v177, v176
    v_mov_b32 v178, v176
    s_nop 1
    v_permlane32_swap_b32 v177, v178
    v_mov_b32 v116, v178
    s_nop 1
    v_permlane16_swap_b32 v178, v116
    v_fma_f32 v176, -v172, v116, v176
    v_mul_f32 v176, v173, v176
    s_nop 1
    v_mov_b32_dpp v177, v176 quad_perm:[1,0,3,2] row_mask:0xf bank_mask:0xf
    v_cvt_pk_bf16_f32 v176, v176, v177
    s_mov_b64 exec, 0x5555
    s_cmp_eq_u32 s16, 0
    s_cbranch_scc1 L_slow_79
    buffer_store_dword v176, v14, s[80:83], s32 offen
L_pubd_80:
    s_mov_b64 exec, -1
    s_add_u32 s31, s31, 8192
    s_add_u32 s32, s32, 8192
L_F_P1:
    s_cmp_lg_u32 s6, 0
    s_cbranch_scc1 L_nq_b1_81
    s_mov_b32 s18, 60000
L_poll_q_82:
    buffer_load_dwordx4 v[136:139], v2, s[80:83], s26 offen sc1
    s_sub_u32 s18, s18, 1
    s_cbranch_scc1 L_bail
    s_waitcnt vmcnt(0)
    v_max3_u32 v220, v136, v137, v138
    v_max_u32 v220, v220, v139
    v_cmp_eq_u32 vcc, -1, v220
    s_cbranch_vccnz L_poll_q_82
    ds_write_b128 v130, v[136:139]
    s_waitcnt lgkmcnt(0)
L_nq_b1_81:
    s_barrier
    ds_read_b128 v[136:139], v130
    s_waitcnt lgkmcnt(0)
    s_nop 0
    v_mfma_f32_16x16x32_bf16 v[180:183], v[16:19], v[136:139], 0
    v_mov_b32_dpp v140, v136 row_ror:12 row_mask:0xf bank_mask:0xf
    v_mov_b32_dpp v141, v137 row_ror:12 row_mask:0xf bank_mask:0xf
    v_mov_b32_dpp v142, v138 row_ror:12 row_mask:0xf bank_mask:0xf
    v_mov_b32_dpp v143, v139 row_ror:12 row_mask:0xf bank_mask:0xf
    v_mfma_f32_16x16x32_bf16 v[184:187], v[32:35], v[136:139], 0
    s_nop 0
    s_nop 0
    v_mfma_f32_16x16x32_bf16 v[180:183], v[20:23], v[140:143], v[180:183]
    v_mov_b32_dpp v144, v136 row_ror:8 row_mask:0xf bank_mask:0xf
    v_mov_b32_dpp v145, v137 row_ror:8 row_mask:0xf bank_mask:0xf
    v_mov_b32_dpp v146, v138 row_ror:8 row_mask:0xf bank_mask:0xf
    v_mov_b32_dpp v147, v139 row_ror:8 row_mask:0xf bank_mask:0xf
    v_mfma_f32_16x16x32_bf16 v[184:187], v[36:39], v[140:143], v[184:187]
    s_nop 0
    s_nop 0
    v_mfma_f32_16x16x32_bf16 v[180:183], v[24:27], v[144:147], v[180:183]
    v_mov_b32_dpp v148, v136 row_ror:4 row_mask:0xf bank_mask:0xf
    v_mov_b32_dpp v149, v137 row_ror:4 row_mask:0xf bank_mask:0xf
    v_mov_b32_dpp v150, v138 row_ror:4 row_mask:0xf bank_mask:0xf
    v_mov_b32_dpp v151, v139 row_ror:4 row_mask:0xf bank_mask:0xf
    v_mfma_f32_16x16x32_bf16 v[184:187], v[40:43], v[144:147], v[184:187]
    s_nop 0
    v_mfma_f32_16x16x32_bf16 v[180:183], v[28:31], v[148:151], v[180:183]
    v_mfma_f32_16x16x32_bf16 v[184:187], v[44:47], v[148:151], v[184:187]
    v_mov_b32 v132, 0
    s_mov_b64 exec, s[8:9]
    s_nop 4
    v_mul_f32 v180, s35, v180
    v_mul_f32 v181, s35, v181
    v_mul_f32 v182, s35, v182
    v_mul_f32 v183, s35, v183
    v_mul_f32 v184, s35, v184
    v_mul_f32 v185, s35, v185
    v_mul_f32 v186, s35, v186
    v_mul_f32 v187, s35, v187
    v_exp_f32 v200, v180
    v_exp_f32 v201, v181
    v_exp_f32 v202, v182
    v_exp_f32 v203, v183
    v_exp_f32 v204, v184
    v_exp_f32 v205, v185
    v_exp_f32 v206, v186
    v_exp_f32 v207, v187
    v_cvt_pk_bf16_f32 v192, v200, v201
    v_cvt_pk_bf16_f32 v193, v202, v203
    v_cvt_pk_bf16_f32 v194, v204, v205
    v_cvt_pk_bf16_f32 v195, v206, v207
    ds_write_b128 v119, v[192:195]
    v_add_f32 v189, v200, v201
    v_add_f32 v196, v202, v203
    v_add_f32 v197, v204, v205
    v_add_f32 v198, v206, v207
    v_max3_f32 v188, |v180|, |v181|, |v182|
    v_add_f32 v189, v189, v196
    v_max3_f32 v190, |v183|, |v184|, |v185|
    v_add_f32 v197, v197, v198
    v_max3_f32 v188, v188, |v186|, |v187|
    v_add_f32 v189, v189, v197
    v_max_f32 v188, v188, v190
    ds_write_b32 v121, v189
    v_cmp_nge_f32 vcc, s3, v188
    s_cbranch_vccnz L_unsafe_85
L_unsafe2_86:
    s_mov_b64 exec, -1
    s_waitcnt lgkmcnt(0)
    s_barrier
    s_nop 0
    ds_read_b128 v[208:211], v120 offset:0
    ds_read_b128 v[212:215], v120 offset:256
    ds_read_b128 v[216:219], v120 offset:512
    ds_read_b128 v[220:223], v120 offset:768
    ds_read_b32 v190, v122
    ds_read_b32 v191, v131 offset:4
    s_waitcnt lgkmcnt(0)
    v_cmp_ne_u32 vcc, 0, v191
    s_cbranch_vccnz L_smax_83
L_sback_84:
    v_mfma_f32_16x16x32_bf16 v[240:243], v[48:51], v[208:211], 0
    v_add_f32_dpp v190, v190, v190 row_ror:4 row_mask:0xf bank_mask:0xf
    s_nop 1
    v_mfma_f32_16x16x32_bf16 v[244:247], v[64:67], v[208:211], 0
    v_add_f32_dpp v190, v190, v190 row_ror:8 row_mask:0xf bank_mask:0xf
    v_mov_b32 v191, v190
    v_mfma_f32_16x16x32_bf16 v[240:243], v[52:55], v[212:215], v[240:243]
    s_nop 0
    v_permlane16_swap_b32 v190, v191
    v_mfma_f32_16x16x32_bf16 v[244:247], v[68:71], v[212:215], v[244:247]
    v_add_f32 v190, v190, v191
    v_mov_b32 v191, v190
    v_mfma_f32_16x16x32_bf16 v[240:243], v[56:59], v[216:219], v[240:243]
    s_nop 0
    v_permlane32_swap_b32 v190, v191
    v_mfma_f32_16x16x32_bf16 v[244:247], v[72:75], v[216:219], v[244:247]
    v_add_f32 v133, v190, v191
    v_mfma_f32_16x16x32_bf16 v[240:243], v[60:63], v[220:223], v[240:243]
    v_mfma_f32_16x16x32_bf16 v[244:247], v[76:79], v[220:223], v[244:247]
    s_nop 6
    s_nop 0
    v_bfi_b32 v240, s15, v127, v240
    v_bfi_b32 v241, s15, v127, v241
    v_bfi_b32 v242, s15, v127, v242
    v_bfi_b32 v243, s15, v127, v243
    v_bfi_b32 v244, s15, v127, v244
    v_bfi_b32 v245, s15, v127, v245
    v_bfi_b32 v246, s15, v127, v246
    v_bfi_b32 v247, s15, v127, v247
    s_mov_b64 exec, s[12:13]
    s_cmp_eq_u32 s16, 0
    s_cbranch_scc1 L_slow_87
    buffer_store_dwordx4 v[132:135], v8, s[80:83], s28 offen
    s_mov_b64 exec, s[8:9]
    buffer_store_dwordx4 v[240:243], v5, s[80:83], s27 offen
    buffer_store_dwordx4 v[244:247], v5, s[80:83], s27 offen offset:16
L_pubd_88:
    s_mov_b64 exec, -1
    s_cmp_ge_u32 s7, 14
    s_cbranch_scc1 L_F_END
    s_cmp_ge_u32 s6, 2
    s_cbranch_scc1 L_F_END
    s_mov_b32 s18, 60000
L_poll_x1_89:
    buffer_load_dwordx4 v[112:115], v2, s[80:83], s31 offen sc1
    buffer_load_dwordx4 v[80:83], v3, s[80:83], s31 offen offset:0 sc1
    buffer_load_dwordx4 v[84:87], v3, s[80:83], s31 offen offset:256 sc1
    buffer_load_dwordx4 v[88:91], v3, s[80:83], s31 offen offset:512 sc1
    buffer_load_dwordx4 v[92:95], v3, s[80:83], s31 offen offset:768 sc1
    s_sub_u32 s18, s18, 1
    s_cbranch_scc1 L_bail
    s_waitcnt vmcnt(0)
    v_max3_u32 v220, v112, v113, v114
    v_max_u32 v220, v220, v115
    v_cmp_eq_u32 vcc, -1, v220
    s_cbranch_vccnz L_poll_x1_89
    s_nop 0
    v_mov_b32 v175, 0x3f803f80
    v_mfma_f32_16x16x32_bf16 v[140:143], v[80:83], a[0:3], 0
    v_dot2_f32_bf16 v172, v112, v175, 0
    v_dot2_f32_bf16 v173, v112, v112, 0
    v_mfma_f32_16x16x32_bf16 v[144:147], v[80:83], a[4:7], 0
    v_dot2_f32_bf16 v172, v113, v175, v172
    v_dot2_f32_bf16 v173, v113, v113, v173
    v_mfma_f32_16x16x32_bf16 v[148:151], v[80:83], a[8:11], 0
    v_dot2_f32_bf16 v172, v114, v175, v172
    v_dot2_f32_bf16 v173, v114, v114, v173
    v_mfma_f32_16x16x32_bf16 v[152:155], v[80:83], a[12:15], 0
    v_dot2_f32_bf16 v172, v115, v175, v172
    v_dot2_f32_bf16 v173, v115, v115, v173
    v_mfma_f32_16x16x32_bf16 v[140:143], v[84:87], a[16:19], v[140:143]
    s_nop 1
    v_permlane32_swap_b32 v172, v173
    v_mfma_f32_16x16x32_bf16 v[144:147], v[84:87], a[20:23], v[144:147]
    v_add_f32 v172, v172, v173
    v_mov_b32 v174, v172
    v_mfma_f32_16x16x32_bf16 v[148:151], v[84:87], a[24:27], v[148:151]
    s_nop 0
    v_permlane16_swap_b32 v172, v174
    v_mfma_f32_16x16x32_bf16 v[152:155], v[84:87], a[28:31], v[152:155]
    v_add_f32 v172, v172, v174
    s_nop 0
    v_mfma_f32_16x16x32_bf16 v[140:143], v[88:91], a[32:35], v[140:143]
    v_add_f32_dpp v172, v172, v172 row_ror:8 row_mask:0xf bank_mask:0xf
    s_nop 0
    v_mfma_f32_16x16x32_bf16 v[144:147], v[88:91], a[36:39], v[144:147]
    v_add_f32_dpp v172, v172, v172 row_ror:4 row_mask:0xf bank_mask:0xf
    s_nop 0
    v_mfma_f32_16x16x32_bf16 v[148:151], v[88:91], a[40:43], v[148:151]
    v_add_f32_dpp v172, v172, v172 row_ror:2 row_mask:0xf bank_mask:0xf
    s_nop 0
    v_mfma_f32_16x16x32_bf16 v[152:155], v[88:91], a[44:47], v[152:155]
    v_add_f32_dpp v172, v172, v172 row_ror:1 row_mask:0xf bank_mask:0xf
    v_mov_b32 v173, v172
    v_mfma_f32_16x16x32_bf16 v[140:143], v[92:95], a[48:51], v[140:143]
    s_nop 0
    v_permlane32_swap_b32 v172, v173
    v_mfma_f32_16x16x32_bf16 v[144:147], v[92:95], a[52:55], v[144:147]
    v_mul_f32 v172, 0x3b000000, v172
    v_mul_f32 v173, 0x3b000000, v173
    v_mfma_f32_16x16x32_bf16 v[148:151], v[92:95], a[56:59], v[148:151]
    v_fma_f32 v173, -v172, v172, v173
    v_max_f32 v173, 0, v173
    v_mfma_f32_16x16x32_bf16 v[152:155], v[92:95], a[60:63], v[152:155]
    v_add_f32 v173, 0x3727c5ac, v173
    v_rsq_f32 v173, v173
    v_add_f32 v176, v140, v145
    s_nop 4
    v_add_f32 v177, v150, v155
    v_add_f32 v176, v176, v177
    v_fma_f32 v176, -v172, v116, v176
    v_mul_f32 v176, v173, v176
    s_nop 1
    v_mov_b32_dpp v177, v176 quad_perm:[1,0,3,2] row_mask:0xf bank_mask:0xf
    v_cvt_pk_bf16_f32 v176, v176, v177
    s_mov_b64 exec, 0x5555
    s_cmp_eq_u32 s16, 0
    s_cbranch_scc1 L_slow_90
    buffer_store_dword v176, v14, s[80:83], s32 offen
L_pubd_91:
    s_mov_b64 exec, -1
L_F_END:
    s_endpgm
L_spare_77:
    s_sub_u32 s20, s7, 14
    s_lshl_b32 s20, s20, 2
    s_add_u32 s20, s20, s6
    s_mul_i32 s20, s20, 28672
    s_mul_i32 s19, s4, 229376
    s_add_u32 s19, s19, s20
    s_mov_b32 m0, 114688
    s_mov_b32 s21, 0
L_w2pre_92:
    s_nop 0
    buffer_load_dwordx4 v2, s[68:71], s19 offen lds
    s_add_u32 s19, s19, 1024
    buffer_load_dwordx4 v2, s[68:71], s19 offen lds
    s_add_u32 s19, s19, 1024
    buffer_load_dwordx4 v2, s[68:71], s19 offen lds
    s_add_u32 s19, s19, 1024
    buffer_load_dwordx4 v2, s[68:71], s19 offen lds
    s_add_u32 s19, s19, 1024
    s_add_u32 s21, s21, 1
    s_cmp_lt_u32 s21, 7
    s_cbranch_scc1 L_w2pre_92
    s_branch L_F_P1
L_unsafe_73:
    v_mov_b32 v190, 115792
    v_mov_b32 v191, 1
    ds_write_b32 v190, v191
    s_branch L_unsafe2_74
L_smax_71:
    v_max3_f32 v188, v180, v181, v182
    v_max3_f32 v189, v183, v184, v185
    v_max3_f32 v188, v188, v186, v187
    v_max_f32 v188, v188, v189
    v_mov_b32 v189, v188
    s_nop 1
    v_permlane16_swap_b32 v188, v189
    v_max_f32 v188, v188, v189
    v_mov_b32 v189, v188
    s_nop 1
    v_permlane32_swap_b32 v188, v189
    v_max_f32 v188, v188, v189
    s_mov_b64 exec, 15
    ds_write_b32 v117, v188
    s_mov_b64 exec, -1
    s_waitcnt lgkmcnt(0)
    s_barrier
    ds_read_b128 v[192:195], v118
    s_waitcnt lgkmcnt(0)
    v_max3_f32 v188, v192, v193, v194
    v_max_f32 v188, v188, v195
    v_mov_b32 v132, v188
    v_sub_f32 v200, v180, v188
    v_sub_f32 v201, v181, v188
    v_sub_f32 v202, v182, v188
    v_sub_f32 v203, v183, v188
    v_sub_f32 v204, v184, v188
    v_sub_f32 v205, v185, v188
    v_sub_f32 v206, v186, v188
    v_sub_f32 v207, v187, v188
    v_exp_f32 v200, v200
    v_exp_f32 v201, v201
    v_exp_f32 v202, v202
    v_exp_f32 v203, v203
    v_exp_f32 v204, v204
    v_exp_f32 v205, v205
    v_exp_f32 v206, v206
    v_exp_f32 v207, v207
    v_cvt_pk_bf16_f32 v192, v200, v201
    v_cvt_pk_bf16_f32 v193, v202, v203
    v_cvt_pk_bf16_f32 v194, v204, v205
    v_cvt_pk_bf16_f32 v195, v206, v207
    v_add_f32 v189, v200, v201
    v_add_f32 v196, v202, v203
    v_add_f32 v197, v204, v205
    v_add_f32 v198, v206, v207
    v_add_f32 v189, v189, v196
    v_add_f32 v197, v197, v198
    v_add_f32 v189, v189, v197
    s_mov_b64 exec, s[8:9]
    ds_write_b128 v119, v[192:195]
    ds_write_b32 v121, v189
    s_mov_b64 exec, -1
    s_waitcnt lgkmcnt(0)
    s_barrier
    ds_read_b128 v[208:211], v120 offset:0
    ds_read_b128 v[212:215], v120 offset:256
    ds_read_b128 v[216:219], v120 offset:512
    ds_read_b128 v[220:223], v120 offset:768
    ds_read_b32 v190, v122
    s_waitcnt lgkmcnt(0)
    s_branch L_sback_72
L_slow_75:
    buffer_store_dwordx4 v[132:135], v8, s[80:83], s28 offen sc1
    s_mov_b64 exec, s[8:9]
    buffer_store_dwordx4 v[240:243], v5, s[80:83], s27 offen sc1
    buffer_store_dwordx4 v[244:247], v5, s[80:83], s27 offen offset:16 sc1
    s_branch L_pubd_76
L_slow_79:
    buffer_store_dword v176, v14, s[80:83], s32 offen sc1
    s_branch L_pubd_80
L_unsafe_85:
    v_mov_b32 v190, 115796
    v_mov_b32 v191, 1
    ds_write_b32 v190, v191
    s_branch L_unsafe2_86
L_smax_83:
    v_max3_f32 v188, v180, v181, v182
    v_max3_f32 v189, v183, v184, v185
    v_max3_f32 v188, v188, v186, v187
    v_max_f32 v188, v188, v189
    v_mov_b32 v189, v188
    s_nop 1
    v_permlane16_swap_b32 v188, v189
    v_max_f32 v188, v188, v189
    v_mov_b32 v189, v188
    s_nop 1
    v_permlane32_swap_b32 v188, v189
    v_max_f32 v188, v188, v189
    s_mov_b64 exec, 15
    ds_write_b32 v117, v188
    s_mov_b64 exec, -1
    s_waitcnt lgkmcnt(0)
    s_barrier
    ds_read_b128 v[192:195], v118
    s_waitcnt lgkmcnt(0)
    v_max3_f32 v188, v192, v193, v194
    v_max_f32 v188, v188, v195
    v_mov_b32 v132, v188
    v_sub_f32 v200, v180, v188
    v_sub_f32 v201, v181, v188
    v_sub_f32 v202, v182, v188
    v_sub_f32 v203, v183, v188
    v_sub_f32 v204, v184, v188
    v_sub_f32 v205, v185, v188
    v_sub_f32 v206, v186, v188
    v_sub_f32 v207, v187, v188
    v_exp_f32 v200, v200
    v_exp_f32 v201, v201
    v_exp_f32 v202, v202
    v_exp_f32 v203, v203
    v_exp_f32 v204, v204
    v_exp_f32 v205, v205
    v_exp_f32 v206, v206
    v_exp_f32 v207, v207
    v_cvt_pk_bf16_f32 v192, v200, v201
    v_cvt_pk_bf16_f32 v193, v202, v203
    v_cvt_pk_bf16_f32 v194, v204, v205
    v_cvt_pk_bf16_f32 v195, v206, v207
    v_add_f32 v189, v200, v201
    v_add_f32 v196, v202, v203
    v_add_f32 v197, v204, v205
    v_add_f32 v198, v206, v207
    v_add_f32 v189, v189, v196
    v_add_f32 v197, v197, v198
    v_add_f32 v189, v189, v197
    s_mov_b64 exec, s[8:9]
    ds_write_b128 v119, v[192:195]
    ds_write_b32 v121, v189
    s_mov_b64 exec, -1
    s_waitcnt lgkmcnt(0)
    s_barrier
    ds_read_b128 v[208:211], v120 offset:0
    ds_read_b128 v[212:215], v120 offset:256
    ds_read_b128 v[216:219], v120 offset:512
    ds_read_b128 v[220:223], v120 offset:768
    ds_read_b32 v190, v122
    s_waitcnt lgkmcnt(0)
    s_branch L_sback_84
L_slow_87:
    buffer_store_dwordx4 v[132:135], v8, s[80:83], s28 offen sc1
    s_mov_b64 exec, s[8:9]
    buffer_store_dwordx4 v[240:243], v5, s[80:83], s27 offen sc1
    buffer_store_dwordx4 v[244:247], v5, s[80:83], s27 offen offset:16 sc1
    s_branch L_pubd_88
L_slow_90:
    buffer_store_dword v176, v14, s[80:83], s32 offen sc1
    s_branch L_pubd_91
L_bail:
    s_endpgm
L_exit:
    s_endpgm
.section .rodata,"a"
.p2align 6
.amdhsa_kernel interleave_layers__sliding_block_cached__glu_gated_swiglu__decode_kernel
  .amdhsa_next_free_vgpr 416
  .amdhsa_next_free_sgpr 102
  .amdhsa_accum_offset 256
  .amdhsa_group_segment_fixed_size 0
  .amdhsa_kernarg_size 96
  .amdhsa_user_sgpr_count 2
  .amdhsa_user_sgpr_kernarg_segment_ptr 1
  .amdhsa_system_sgpr_workgroup_id_x 1
  .amdhsa_float_denorm_mode_32 3
.end_amdhsa_kernel
```
